```python
import torch

def _softmax(x, axis=-1):
    return torch.softmax(x, dim=axis)
def _gelu(x):
    return torch.nn.functional.gelu(x, approximate="tanh")
def _silu(x):
    return torch.nn.functional.silu(x)
def _sigmoid(x):
    return torch.sigmoid(x)
def _layernorm(x, axis=-1, eps=1e-5):
    m = x.mean(dim=axis, keepdim=True)
    v = x.var(dim=axis, keepdim=True, unbiased=False)
    return (x - m) / torch.sqrt(v + eps)
def _scatter_add(tgt, idx, src, axis=0):
    return tgt.clone().index_add_(axis, idx, src)
def _segment_sum(src, seg, n):
    out = torch.zeros((n,) + src.shape[1:], dtype=src.dtype)
    return out.index_add_(0, seg, src)
def _pad(x, pw):
    flat = tuple(v for pair in reversed(pw) for v in pair)
    return torch.nn.functional.pad(x, flat)

kernel_name = 'standalone__sequential_behavior_din__recsys'

def setup_inputs():

    _w = (lambda a: (lambda t: t.to(torch.bfloat16) if t.is_floating_point() else t)(torch.as_tensor(a)))
    B, L, D = 1024, 200, 128
    H = D
    return {
        "target": _w((lambda *s: torch.randn(*s, dtype=torch.bfloat16) * 1.6)(B, D)),
        "hist": _w((lambda *s: torch.randn(*s, dtype=torch.bfloat16) * 1.6)(B, L, D)),
        "mask": _w((lambda lo, hi, *s: torch.randint(lo, hi, s))(0, 2, B, L).to(float)),
        "w1": _w((lambda *s: torch.randn(*s, dtype=torch.bfloat16) * 1.6)(4 * D, H) * (4 * D) ** -0.5),
        "b1": _w((lambda *s: torch.randn(*s, dtype=torch.bfloat16) * 1.6)(H) * 0.1),
        "w2": _w((lambda *s: torch.randn(*s, dtype=torch.bfloat16) * 0.05)(H, 1) * H ** -0.5),
        "b2": _w((lambda *s: torch.randn(*s, dtype=torch.bfloat16) * 0.05)(1) * 0.1),
    }

def reference(target, hist, mask, w1, b1, w2, b2):
    L = hist.shape[1]
    tgt = (lambda x, n, axis: torch.repeat_interleave(x, n, dim=axis))(target[:, None, :], L, axis=1)
    feat = torch.concatenate([hist, tgt, hist - tgt, hist * tgt], axis=-1)
    h = _sigmoid(feat @ w1 + b1)
    scores = (h @ w2 + b2)[..., 0] * mask
    return torch.einsum('bl,bld->bd', scores, hist)
```

```asm
; @launch grid=(256,1,1) block=(512,1,1) lds=163584
.amdgcn_target "amdgcn-amd-amdhsa--gfx950"
.text
.globl standalone__sequential_behavior_din__recsys_kernel
.p2align 12
.p2align 8
.type standalone__sequential_behavior_din__recsys_kernel,@function
standalone__sequential_behavior_din__recsys_kernel:
L_entry:
    s_cmp_ge_u32 s2, 256
    s_cbranch_scc1 L_exit
    s_load_dwordx16 s[4:19], s[0:1], 0
    s_getpc_b64 s[66:67]
    s_getreg_b32 s70, hwreg(HW_REG_HW_ID, 8, 8)
    s_bfe_u32 s31, s70, 0x20005
    s_and_b32 s70, s70, 7
    s_lshl3_add_u32 s70, s31, s70
    v_lshrrev_b32 v151, 6, v0
    v_and_b32 v148, 63, v0
    v_readfirstlane_b32 s28, v151
    s_mov_b32 s31, s70
    s_mul_i32 s31, s31, 640
    v_lshl_add_u32 v153, v148, 7, s31
    s_cmp_lg_u32 s28, 0
    s_cbranch_scc1 L_nopf
    s_mov_b64 exec, 0x1f
    global_load_dword v94, v153, s[66:67]
    s_mov_b64 exec, -1
L_nopf:
    v_lshrrev_b32 v149, 4, v148
    v_and_b32 v150, 15, v148
    s_mul_i32 s34, s28, 1088
    s_xor_b32 s28, s28, 4
    s_lshr_b32 s29, s28, 2
    s_and_b32 s30, s28, 3
    v_lshlrev_b32 v151, 2, v149
    v_xor_b32 v151, v151, v150
    v_lshlrev_b32 v151, 4, v151
    v_lshl_add_u32 v89, v149, 8, v151
    v_xor_b32 v90, 32, v89
    v_lshlrev_b32 v155, 4, v148
    s_lshl_b32 s74, s30, 13
    s_lshl_b32 s75, s30, 15
    s_mov_b32 s26, 131072
    s_mov_b32 s27, 0x20000
    s_lshl_b32 s32, s2, 2
    s_add_u32 s32, s32, s30
    s_mul_i32 s40, s32, 400
    s_lshl_b32 s41, s32, 8
    s_mul_i32 s3, s30, 320
    s_lshl_b32 s46, s30, 6
    s_lshl_b32 s47, s28, 5
    v_lshlrev_b32 v154, 3, v148
    v_mov_b32 v68, 0
    v_mov_b32 v69, 0
    v_mov_b32 v100, 0
    v_mov_b32 v101, 0
    v_mov_b32 v102, 0
    v_mov_b32 v103, 0
    v_add_u32 v151, s34, v155
    v_lshlrev_b32 v152, 4, v0
    v_add_u32 v152, 148480, v152
    s_mov_b32 s31, s70
    s_lshl_b32 s31, s31, 12
    s_lshl_b32 s32, s30, 10
    s_add_u32 s31, s31, s32
    v_lshl_add_u32 v95, v148, 7, s31
    s_mov_b32 s31, s70
    s_mul_i32 s43, s31, 768
    s_add_u32 s43, s43, s75
    s_add_u32 s43, s43, 8192
    s_lshl_b32 s31, s31, 3
    s_add_u32 s31, s31, s28
    s_lshl_b32 s68, s31, 6
    s_add_u32 s68, s68, 3072
    ds_write_b128 v152, v[100:103]
    v_bfe_u32 v156, v148, 2, 2
    v_and_b32 v157, 3, v148
    v_lshrrev_b32 v158, 5, v148
    v_and_b32 v159, 31, v148
    v_lshrrev_b32 v161, 1, v157
    v_and_b32 v160, 1, v157
    s_mov_b32 s22, 204800
    s_mov_b32 s23, 0x20000
    s_lshl_b32 s35, s28, 12
    s_lshr_b32 s36, s28, 1
    s_lshl_b32 s36, s36, 15
    s_and_b32 s31, s35, 0x1000
    s_add_u32 s36, s36, s31
    s_mov_b32 s78, 0x8000
    s_waitcnt lgkmcnt(0)
    s_mov_b32 s24, s10
    s_mov_b32 s25, s11
    s_add_u32 s4, s4, s41
    s_addc_u32 s5, s5, 0
    s_add_u32 s8, s8, s40
    s_addc_u32 s9, s9, 0
    s_cmp_lg_u32 s29, 0
    s_cbranch_scc1 L_a1
L_a0:
    s_add_u32 m0, s74, 21504
    s_add_u32 s37, s75, 4096
    buffer_load_dwordx4 v89, s[24:27], s37 offen offset:0 lds
    buffer_load_dwordx4 v89, s[24:27], s37 offen offset:1024 lds
    buffer_load_dwordx4 v90, s[24:27], s37 offen offset:2048 lds
    buffer_load_dwordx4 v90, s[24:27], s37 offen offset:3072 lds
    s_branch L_a2
L_a1:
    s_add_u32 m0, s3, 162304
    s_mov_b64 exec, 0xffff
    global_load_lds_dwordx4 v155, s[4:5]
    s_mov_b64 exec, -1
    s_mov_b32 exec_hi, 0x3ffff
    global_load_dwordx2 v[68:69], v154, s[8:9]
    s_mov_b32 exec_hi, -1
    v_lshl_add_u32 v95, v148, 7, s43
    s_mov_b64 exec, 0x3f
    global_load_dword v94, v95, s[10:11]
    s_mov_b64 exec, -1
    s_add_u32 m0, s74, 17408
    s_add_u32 s37, s75, 0
    buffer_load_dwordx4 v89, s[24:27], s37 offen offset:0 lds
    buffer_load_dwordx4 v89, s[24:27], s37 offen offset:1024 lds
    buffer_load_dwordx4 v90, s[24:27], s37 offen offset:2048 lds
    buffer_load_dwordx4 v90, s[24:27], s37 offen offset:3072 lds
    s_mul_i32 s31, s30, 200
    v_lshl_add_u32 v76, v148, 2, s31
    v_add_u32 v77, 1, v76
    v_add_u32 v78, 2, v76
    v_add_u32 v79, 3, v76
    v_mov_b32 v80, 0
    s_mul_i32 s33, s30, 896
    s_add_u32 s33, s33, 156672
    v_add_u32 v81, s33, v155
    v_mov_b32 v72, 0xffff
    v_mov_b32 v73, 0xffff
    v_mov_b32 v74, 0xffff
    v_mov_b32 v75, 0xffff
    s_mov_b32 s73, 0xffff0000
    s_mov_b32 exec_hi, 0xffffff
    ds_write_b128 v81, v[72:75]
    s_mov_b32 exec_hi, -1
    s_add_u32 s33, s33, 896
    v_lshlrev_b32 v82, 2, v148
    v_add_u32 v82, 160256, v82
L_a2:
    s_add_u32 s14, s14, s46
    s_addc_u32 s15, s15, 0
    s_add_u32 s12, s12, s47
    s_addc_u32 s13, s13, 0
    s_load_dword s72, s[16:17], 0
    s_load_dwordx8 s[56:63], s[12:13], 0
    s_load_dwordx16 s[40:55], s[14:15], 0
    s_mul_i32 s31, s2, 204800
    s_add_u32 s20, s6, s31
    s_addc_u32 s21, s7, 0
    s_lshl_b32 s77, s2, 10
    s_add_u32 s18, s18, s77
    s_addc_u32 s19, s19, 0
    v_xor_b32 v153, s30, v156
    v_lshlrev_b32 v153, 6, v153
    v_lshl_add_u32 v152, v158, 3, v156
    v_lshl_add_u32 v151, v152, 8, v153
    v_and_b32 v152, 1, v149
    v_xor_b32 v153, v152, v158
    v_lshl_add_u32 v151, v153, 5, v151
    v_lshl_add_u32 v151, v157, 3, v151
    v_add_u32 v84, 17408, v151
    v_add_u32 v85, 82944, v151
    s_lshr_b32 s31, s28, 1
    v_xor_b32 v153, s31, v156
    v_lshlrev_b32 v153, 6, v153
    s_and_b32 s31, s28, 1
    v_xor_b32 v152, s31, v152
    v_lshl_add_u32 v153, v152, 5, v153
    v_lshl_add_u32 v152, v149, 3, v156
    v_lshl_add_u32 v151, v152, 8, v153
    v_lshl_add_u32 v151, v157, 3, v151
    v_add_u32 v86, 17408, v151
    v_add_u32 v87, 82944, v151
    v_mov_b32 v162, 0x78
    v_lshlrev_b32 v151, 4, v160
    v_mov_b32 v153, 0xffff
    v_lshlrev_b32 v151, v151, v153
    s_mov_b32 s38, 0x30003
    s_mov_b32 s39, 0x300030
    v_cndmask_b32 v204, 0, v151, s[38:39]
    v_and_b32 v200, 0x3f803f80, v204
    s_mov_b32 s38, 0xc000c
    s_mov_b32 s39, 0xc000c0
    v_cndmask_b32 v205, 0, v151, s[38:39]
    v_and_b32 v201, 0x3f803f80, v205
    s_mov_b32 s38, 0x3000300
    s_mov_b32 s39, 0x30003000
    v_cndmask_b32 v206, 0, v151, s[38:39]
    v_and_b32 v202, 0x3f803f80, v206
    s_mov_b32 s38, 0xc000c00
    s_mov_b32 s39, 0xc000c000
    v_cndmask_b32 v207, 0, v151, s[38:39]
    v_and_b32 v203, 0x3f803f80, v207
    v_mul_u32_u24 v151, 320, v157
    v_lshl_add_u32 v151, v149, 4, v151
    v_add_u32 v88, 162304, v151
    v_mov_b32 v251, 0xbfb8aa3b
    v_bfe_u32 v153, v148, 2, 1
    v_lshl_add_u32 v151, v153, 2, v161
    v_bfe_u32 v153, v148, 3, 1
    v_lshl_add_u32 v151, v153, 1, v151
    v_and_b32 v153, 1, v149
    v_mul_u32_u24 v153, 80, v153
    v_add_u32 v151, v151, v153
    s_mul_i32 s76, s29, 640
    s_add_u32 s76, s76, 162304
    v_lshl_add_u32 v252, v151, 2, s76
    s_lshl_b32 s76, s29, 10
    s_lshl_b32 s31, s30, 7
    s_add_u32 s31, s31, s76
    s_add_u32 s31, s31, 160256
    v_lshl_add_u32 v249, v158, 4, s31
    v_xor_b32 v254, v150, v149
    v_lshlrev_b32 v254, 4, v254
    s_xor_b32 s31, s28, 4
    s_lshl_b32 s31, s31, 4
    s_add_u32 s31, s31, 156672
    v_lshl_add_u32 v253, v149, 2, s31
    v_lshlrev_b32 v151, 9, v157
    v_lshl_add_u32 v151, v149, 4, v151
    s_lshl_b32 s31, s28, 6
    s_add_u32 s31, s31, 160256
    v_add_u32 v93, s31, v151
    v_mul_u32_u24 v151, 896, v157
    v_add_u32 v83, 157052, v151
    s_mul_i32 s76, s29, 8704
    v_lshrrev_b32 v151, 2, v159
    v_mul_u32_u24 v151, 1088, v151
    v_lshl_add_u32 v151, v157, 8, v151
    v_xor_b32 v153, v158, v157
    v_lshl_add_u32 v151, v153, 4, v151
    v_add_u32 v232, s76, v151
    v_xor_b32 v234, 32, v232
    v_add_u32 v233, 69632, v232
    v_add_u32 v235, 69632, v234
    v_lshrrev_b32 v151, 1, v156
    v_lshl_add_u32 v151, v149, 1, v151
    v_mul_u32_u24 v151, 1088, v151
    v_and_b32 v153, 1, v156
    v_lshl_add_u32 v151, v153, 9, v151
    v_lshlrev_b32 v153, 1, v153
    v_xor_b32 v153, v153, v161
    v_lshl_add_u32 v151, v153, 4, v151
    v_lshl_add_u32 v151, v160, 3, v151
    s_lshl_b32 s31, s30, 6
    s_add_u32 s31, s31, s76
    v_add_u32 v236, s31, v151
    v_xor_b32 v237, 16, v236
    v_xor_b32 v238, 32, v236
    v_xor_b32 v239, 48, v236
    v_add_u32 v240, 69632, v236
    v_add_u32 v241, 69632, v237
    v_add_u32 v242, 69632, v238
    v_add_u32 v243, 69632, v239
    v_bfe_u32 v151, v148, 1, 2
    v_lshl_add_u32 v151, v160, 2, v151
    v_lshlrev_b32 v151, 1, v151
    v_lshrrev_b32 v153, 3, v159
    s_and_b32 s31, s30, 2
    v_xor_b32 v153, s31, v153
    v_lshl_add_u32 v151, v153, 4, v151
    v_lshl_add_u32 v151, v158, 6, v151
    s_lshl_b32 s76, s29, 12
    s_add_u32 s76, s76, 148480
    s_lshl_b32 s31, s30, 7
    s_add_u32 s31, s31, s76
    v_add_u32 v244, s31, v151
    v_xor_b32 v247, 48, v244
    v_lshlrev_b32 v153, 1, v156
    v_lshrrev_b32 v153, v153, v162
    v_and_b32 v153, 3, v153
    v_xor_b32 v153, v153, v149
    v_lshlrev_b32 v151, 6, v150
    v_lshl_add_u32 v151, v153, 4, v151
    v_add_u32 v245, s76, v151
    s_mul_i32 s31, s29, 1792
    s_add_u32 s31, s31, 156672
    v_lshl_add_u32 v246, v159, 2, s31
    s_cmp_lg_u32 s29, 0
    s_cbranch_scc1 L_g1
L_c0:
L_g0:
    s_add_u32 m0, s74, 54272
    s_add_u32 s37, s75, 12288
    buffer_load_dwordx4 v89, s[24:27], s37 offen offset:0 lds
    buffer_load_dwordx4 v89, s[24:27], s37 offen offset:1024 lds
    buffer_load_dwordx4 v90, s[24:27], s37 offen offset:2048 lds
    buffer_load_dwordx4 v90, s[24:27], s37 offen offset:3072 lds
    s_setprio 1
    s_waitcnt lgkmcnt(0)
    v_mov_b32 v154, s40
    v_mov_b32 v155, s41
    v_mov_b32 v156, s44
    v_mov_b32 v157, s45
    v_mov_b32 v158, s48
    v_mov_b32 v159, s49
    v_mov_b32 v160, s52
    v_mov_b32 v161, s53
    v_mov_b32 v162, s56
    v_mov_b32 v163, s57
    s_lshl_b32 s76, s72, 16
    s_cmp_eq_u32 s30, 0
    s_cselect_b32 s76, s76, 0
    v_mov_b32 v248, s76
    s_mov_b32 exec_lo, 0xffff0000
    v_mov_b32 v162, s58
    v_mov_b32 v163, s59
    s_mov_b32 exec_lo, 0
    v_mov_b32 v154, s42
    v_mov_b32 v155, s43
    v_mov_b32 v156, s46
    v_mov_b32 v157, s47
    v_mov_b32 v158, s50
    v_mov_b32 v159, s51
    v_mov_b32 v160, s54
    v_mov_b32 v161, s55
    v_mov_b32 v248, 0
    v_mov_b32 v162, s60
    v_mov_b32 v163, s61
    s_mov_b32 exec_hi, 0xffff0000
    v_mov_b32 v162, s62
    v_mov_b32 v163, s63
    s_mov_b64 exec, -1
    v_lshlrev_b32 v100, 16, v154
    v_and_b32 v101, 0xffff0000, v154
    v_lshlrev_b32 v102, 16, v155
    v_and_b32 v103, 0xffff0000, v155
    v_lshlrev_b32 v104, 16, v156
    v_and_b32 v105, 0xffff0000, v156
    v_lshlrev_b32 v106, 16, v157
    v_and_b32 v107, 0xffff0000, v157
    v_lshlrev_b32 v108, 16, v158
    v_and_b32 v109, 0xffff0000, v158
    v_lshlrev_b32 v110, 16, v159
    v_and_b32 v111, 0xffff0000, v159
    v_lshlrev_b32 v112, 16, v160
    v_and_b32 v113, 0xffff0000, v160
    v_lshlrev_b32 v114, 16, v161
    v_and_b32 v115, 0xffff0000, v161
    v_lshlrev_b32 v96, 16, v162
    v_and_b32 v97, 0xffff0000, v162
    v_lshlrev_b32 v98, 16, v163
    v_and_b32 v99, 0xffff0000, v163
    v_fmaak_f32 v96, v96, v251, 0xc2200000
    v_fmaak_f32 v97, v97, v251, 0xc2200000
    v_fmaak_f32 v98, v98, v251, 0xc2200000
    v_fmaak_f32 v99, v99, v251, 0xc2200000
    v_mul_f32 v248, 0x53800000, v248
    s_waitcnt vmcnt(4)
    s_barrier
    ds_read2_b32 v[188:189], v252 offset0:0 offset1:8
    ds_read_b64_tr_b16 v[116:117], v84 offset:0
    ds_read_b64_tr_b16 v[118:119], v84 offset:1024
    ds_read_b64_tr_b16 v[124:125], v84 offset:16384
    ds_read_b64_tr_b16 v[126:127], v84 offset:17408
    ds_read_b64_tr_b16 v[132:133], v84 offset:24576
    ds_read_b64_tr_b16 v[134:135], v84 offset:25600
    ds_read_b64_tr_b16 v[120:121], v84 offset:4096
    ds_read_b64_tr_b16 v[122:123], v84 offset:5120
    ds_read_b64_tr_b16 v[128:129], v84 offset:20480
    ds_read_b64_tr_b16 v[130:131], v84 offset:21504
    ds_read_b64_tr_b16 v[136:137], v84 offset:28672
    ds_read_b64_tr_b16 v[138:139], v84 offset:29696
    ds_read_b128 v[196:199], v88 offset:0
    ds_read_b64_tr_b16 v[140:141], v86 offset:8192
    s_waitcnt lgkmcnt(11)
    ds_read_b64_tr_b16 v[142:143], v86 offset:9216
    ds_read_b64_tr_b16 v[144:145], v86 offset:16384
    ds_read_b64_tr_b16 v[146:147], v86 offset:17408
    ds_read2_b32 v[190:191], v252 offset0:16 offset1:24
    s_waitcnt lgkmcnt(11)
    ds_read2_b32 v[192:193], v252 offset0:32 offset1:40
    ds_read2_b32 v[194:195], v252 offset0:48 offset1:56
    v_mfma_f32_32x32x16_bf16 v[164:179], v[200:203], v[116:119], 0
    v_and_b32 v180, v188, v204
    v_and_b32 v181, v188, v205
    v_and_b32 v182, v188, v206
    v_and_b32 v183, v188, v207
    s_nop 0
    v_mfma_f32_32x32x16_bf16 v[164:179], v[200:203], v[124:127], v[164:179]
    v_mfma_f32_32x32x16_bf16 v[164:179], v[180:183], v[132:135], v[164:179]
    s_waitcnt lgkmcnt(12)
    v_mfma_f32_32x32x16_bf16 v[216:231], v[200:203], v[120:123], 0
    s_waitcnt lgkmcnt(3)
    v_mfma_f32_16x16x32_bf16 v[208:211], v[140:143], v[196:199], 0
    v_mfma_f32_16x16x32_bf16 v[212:215], v[144:147], v[196:199], 0
    v_and_b32 v184, v189, v204
    v_and_b32 v185, v189, v205
    v_and_b32 v186, v189, v206
    v_and_b32 v187, v189, v207
    s_add_u32 m0, s35, 82944
    s_add_u32 s37, s36, 16384
    buffer_load_dwordx4 v89, s[24:27], s37 offen offset:0 lds
    buffer_load_dwordx4 v89, s[24:27], s37 offen offset:1024 lds
    v_mul_f32 v164, v251, v164
    v_mul_f32 v165, v251, v165
    v_mul_f32 v166, v251, v166
    v_mul_f32 v167, v251, v167
    v_mul_f32 v168, v251, v168
    v_mul_f32 v169, v251, v169
    v_mfma_f32_32x32x16_bf16 v[216:231], v[200:203], v[128:131], v[216:231]
    v_mul_f32 v170, v251, v170
    v_mul_f32 v171, v251, v171
    v_cvt_pk_bf16_f32 v4, v164, v165
    v_cvt_pk_bf16_f32 v5, v166, v167
    v_cvt_pk_bf16_f32 v6, v168, v169
    v_cvt_pk_bf16_f32 v7, v170, v171
    v_mul_f32 v172, v251, v172
    v_mul_f32 v173, v251, v173
    v_mul_f32 v174, v251, v174
    v_mfma_f32_32x32x16_bf16 v[216:231], v[184:187], v[136:139], v[216:231]
    v_mul_f32 v175, v251, v175
    v_mul_f32 v176, v251, v176
    v_mul_f32 v177, v251, v177
    v_mul_f32 v178, v251, v178
    v_mul_f32 v179, v251, v179
    v_cvt_pk_bf16_f32 v36, v172, v173
    v_cvt_pk_bf16_f32 v37, v174, v175
    v_cvt_pk_bf16_f32 v38, v176, v177
    v_cvt_pk_bf16_f32 v39, v178, v179
    buffer_load_dwordx4 v90, s[24:27], s37 offen offset:2048 lds
    buffer_load_dwordx4 v90, s[24:27], s37 offen offset:3072 lds
    s_waitcnt vmcnt(4)
    s_barrier
    ds_read_b64_tr_b16 v[116:117], v84 offset:32768
    ds_read_b64_tr_b16 v[118:119], v84 offset:33792
    ds_read_b64_tr_b16 v[124:125], v84 offset:49152
    ds_read_b64_tr_b16 v[126:127], v84 offset:50176
    s_add_u32 m0, s35, 115712
    s_add_u32 s37, s36, 24576
    buffer_load_dwordx4 v89, s[24:27], s37 offen offset:0 lds
    ds_read_b64_tr_b16 v[132:133], v84 offset:57344
    ds_read_b64_tr_b16 v[134:135], v84 offset:58368
    ds_read_b64_tr_b16 v[120:121], v84 offset:36864
    ds_read_b64_tr_b16 v[122:123], v84 offset:37888
    buffer_load_dwordx4 v89, s[24:27], s37 offen offset:1024 lds
    ds_read_b64_tr_b16 v[128:129], v84 offset:53248
    ds_read_b64_tr_b16 v[130:131], v84 offset:54272
    ds_read_b64_tr_b16 v[136:137], v84 offset:61440
    ds_read_b64_tr_b16 v[138:139], v84 offset:62464
    buffer_load_dwordx4 v90, s[24:27], s37 offen offset:2048 lds
    s_waitcnt lgkmcnt(11)
    ds_read_b128 v[196:199], v88 offset:64
    ds_read_b64_tr_b16 v[140:141], v86 offset:40960
    ds_read_b64_tr_b16 v[142:143], v86 offset:41984
    ds_read_b64_tr_b16 v[144:145], v86 offset:49152
    s_waitcnt lgkmcnt(11)
    ds_read_b64_tr_b16 v[146:147], v86 offset:50176
    buffer_load_dwordx4 v90, s[24:27], s37 offen offset:3072 lds
    ds_read_u16 v148, v253 offset:384
    ds_read_u16 v149, v253 offset:2176
    ds_read_u16 v150, v253 offset:1280
    s_waitcnt lgkmcnt(11)
    ds_read_u16 v151, v253 offset:3072
    ds_read_u16 v152, v253 offset:512
    v_mfma_f32_32x32x16_bf16 v[164:179], v[200:203], v[116:119], 0
    v_and_b32 v180, v190, v204
    v_and_b32 v181, v190, v205
    v_and_b32 v182, v190, v206
    v_and_b32 v183, v190, v207
    v_mul_f32 v216, v251, v216
    v_mul_f32 v217, v251, v217
    v_mul_f32 v218, v251, v218
    v_mul_f32 v219, v251, v219
    v_mul_f32 v220, v251, v220
    v_mfma_f32_32x32x16_bf16 v[164:179], v[200:203], v[124:127], v[164:179]
    v_mul_f32 v221, v251, v221
    v_mul_f32 v222, v251, v222
    v_mul_f32 v223, v251, v223
    v_cvt_pk_bf16_f32 v8, v216, v217
    v_cvt_pk_bf16_f32 v9, v218, v219
    v_cvt_pk_bf16_f32 v10, v220, v221
    v_cvt_pk_bf16_f32 v11, v222, v223
    v_mul_f32 v224, v251, v224
    v_mul_f32 v225, v251, v225
    v_mul_f32 v226, v251, v226
    v_mfma_f32_32x32x16_bf16 v[164:179], v[180:183], v[132:135], v[164:179]
    v_mul_f32 v227, v251, v227
    v_mul_f32 v228, v251, v228
    v_mul_f32 v229, v251, v229
    v_mul_f32 v230, v251, v230
    v_mul_f32 v231, v251, v231
    v_cvt_pk_bf16_f32 v40, v224, v225
    v_cvt_pk_bf16_f32 v41, v226, v227
    v_cvt_pk_bf16_f32 v42, v228, v229
    v_cvt_pk_bf16_f32 v43, v230, v231
    v_mfma_f32_32x32x16_bf16 v[216:231], v[200:203], v[120:123], 0
    s_waitcnt lgkmcnt(5)
    v_mfma_f32_16x16x32_bf16 v[208:211], v[140:143], v[196:199], v[208:211]
    v_mfma_f32_16x16x32_bf16 v[212:215], v[144:147], v[196:199], v[212:215]
    v_and_b32 v184, v191, v204
    v_and_b32 v185, v191, v205
    v_and_b32 v186, v191, v206
    v_and_b32 v187, v191, v207
    s_waitcnt lgkmcnt(0)
    v_lshl_add_u32 v148, v148, 8, v254
    v_lshl_add_u32 v149, v149, 8, v254
    v_lshl_add_u32 v150, v150, 8, v254
    v_lshl_add_u32 v151, v151, 8, v254
    v_lshl_add_u32 v152, v152, 8, v254
    v_mul_f32 v164, v251, v164
    v_mul_f32 v165, v251, v165
    v_mul_f32 v166, v251, v166
    v_mul_f32 v167, v251, v167
    v_mul_f32 v168, v251, v168
    v_mul_f32 v169, v251, v169
    v_mfma_f32_32x32x16_bf16 v[216:231], v[200:203], v[128:131], v[216:231]
    v_mul_f32 v170, v251, v170
    v_mul_f32 v171, v251, v171
    v_cvt_pk_bf16_f32 v12, v164, v165
    v_cvt_pk_bf16_f32 v13, v166, v167
    v_cvt_pk_bf16_f32 v14, v168, v169
    v_cvt_pk_bf16_f32 v15, v170, v171
    v_mul_f32 v172, v251, v172
    v_mul_f32 v173, v251, v173
    v_mul_f32 v174, v251, v174
    v_mfma_f32_32x32x16_bf16 v[216:231], v[184:187], v[136:139], v[216:231]
    v_mul_f32 v175, v251, v175
    v_mul_f32 v176, v251, v176
    v_mul_f32 v177, v251, v177
    v_mul_f32 v178, v251, v178
    v_mul_f32 v179, v251, v179
    v_cvt_pk_bf16_f32 v44, v172, v173
    v_cvt_pk_bf16_f32 v45, v174, v175
    v_cvt_pk_bf16_f32 v46, v176, v177
    v_cvt_pk_bf16_f32 v47, v178, v179
    s_waitcnt vmcnt(4)
    s_waitcnt lgkmcnt(0)
    s_barrier
    ds_read_b64_tr_b16 v[116:117], v85 offset:0
    ds_read_b64_tr_b16 v[118:119], v85 offset:1024
    ds_read_b64_tr_b16 v[124:125], v85 offset:16384
    ds_read_b64_tr_b16 v[126:127], v85 offset:17408
    s_add_u32 m0, s34, 0
    s_nop 0
    buffer_load_dwordx4 v148, s[20:23], 0 offen nt lds
    s_add_u32 m0, s34, 8704
    s_nop 0
    buffer_load_dwordx4 v149, s[20:23], 0 offen nt lds
    ds_read_b64_tr_b16 v[132:133], v85 offset:24576
    ds_read_b64_tr_b16 v[134:135], v85 offset:25600
    ds_read_b64_tr_b16 v[120:121], v85 offset:4096
    ds_read_b64_tr_b16 v[122:123], v85 offset:5120
    s_add_u32 m0, s34, 17408
    s_nop 0
    buffer_load_dwordx4 v150, s[20:23], 0 offen nt lds
    ds_read_b64_tr_b16 v[128:129], v85 offset:20480
    ds_read_b64_tr_b16 v[130:131], v85 offset:21504
    ds_read_b64_tr_b16 v[136:137], v85 offset:28672
    ds_read_b64_tr_b16 v[138:139], v85 offset:29696
    s_add_u32 m0, s34, 26112
    s_nop 0
    buffer_load_dwordx4 v151, s[20:23], 0 offen nt lds
    ds_read_b128 v[196:199], v88 offset:128
    ds_read_b64_tr_b16 v[140:141], v87 offset:8192
    ds_read_b64_tr_b16 v[142:143], v87 offset:9216
    s_waitcnt lgkmcnt(11)
    ds_read_b64_tr_b16 v[144:145], v87 offset:16384
    ds_read_b64_tr_b16 v[146:147], v87 offset:17408
    s_add_u32 m0, s34, 34816
    s_nop 0
    buffer_load_dwordx4 v152, s[20:23], 0 offen nt lds
    ds_read_u16 v153, v253 offset:2304
    ds_read_u16 v154, v253 offset:640
    s_waitcnt lgkmcnt(11)
    ds_read_u16 v70, v83
    v_mfma_f32_32x32x16_bf16 v[164:179], v[200:203], v[116:119], 0
    v_and_b32 v180, v192, v204
    v_and_b32 v181, v192, v205
    v_and_b32 v182, v192, v206
    v_and_b32 v183, v192, v207
    v_mul_f32 v216, v251, v216
    v_mul_f32 v217, v251, v217
    v_mul_f32 v218, v251, v218
    v_mul_f32 v219, v251, v219
    v_mul_f32 v220, v251, v220
    v_mfma_f32_32x32x16_bf16 v[164:179], v[200:203], v[124:127], v[164:179]
    v_mul_f32 v221, v251, v221
    v_mul_f32 v222, v251, v222
    v_mul_f32 v223, v251, v223
    v_cvt_pk_bf16_f32 v16, v216, v217
    v_cvt_pk_bf16_f32 v17, v218, v219
    v_cvt_pk_bf16_f32 v18, v220, v221
    v_cvt_pk_bf16_f32 v19, v222, v223
    v_mul_f32 v224, v251, v224
    v_mul_f32 v225, v251, v225
    v_mul_f32 v226, v251, v226
    v_mfma_f32_32x32x16_bf16 v[164:179], v[180:183], v[132:135], v[164:179]
    v_mul_f32 v227, v251, v227
    v_mul_f32 v228, v251, v228
    v_mul_f32 v229, v251, v229
    v_mul_f32 v230, v251, v230
    v_mul_f32 v231, v251, v231
    v_cvt_pk_bf16_f32 v48, v224, v225
    v_cvt_pk_bf16_f32 v49, v226, v227
    v_cvt_pk_bf16_f32 v50, v228, v229
    v_cvt_pk_bf16_f32 v51, v230, v231
    v_mfma_f32_32x32x16_bf16 v[216:231], v[200:203], v[120:123], 0
    s_waitcnt lgkmcnt(3)
    v_mfma_f32_16x16x32_bf16 v[208:211], v[140:143], v[196:199], v[208:211]
    v_mfma_f32_16x16x32_bf16 v[212:215], v[144:147], v[196:199], v[212:215]
    v_and_b32 v184, v193, v204
    v_and_b32 v185, v193, v205
    v_and_b32 v186, v193, v206
    v_and_b32 v187, v193, v207
    s_waitcnt lgkmcnt(1)
    v_lshl_add_u32 v153, v153, 8, v254
    v_lshl_add_u32 v154, v154, 8, v254
    v_mul_f32 v164, v251, v164
    v_mul_f32 v165, v251, v165
    v_mul_f32 v166, v251, v166
    v_mul_f32 v167, v251, v167
    v_mul_f32 v168, v251, v168
    v_mul_f32 v169, v251, v169
    v_mfma_f32_32x32x16_bf16 v[216:231], v[200:203], v[128:131], v[216:231]
    v_mul_f32 v170, v251, v170
    v_mul_f32 v171, v251, v171
    v_cvt_pk_bf16_f32 v20, v164, v165
    v_cvt_pk_bf16_f32 v21, v166, v167
    v_cvt_pk_bf16_f32 v22, v168, v169
    v_cvt_pk_bf16_f32 v23, v170, v171
    v_mul_f32 v172, v251, v172
    v_mul_f32 v173, v251, v173
    v_mul_f32 v174, v251, v174
    v_mfma_f32_32x32x16_bf16 v[216:231], v[184:187], v[136:139], v[216:231]
    v_mul_f32 v175, v251, v175
    v_mul_f32 v176, v251, v176
    v_mul_f32 v177, v251, v177
    v_mul_f32 v178, v251, v178
    v_mul_f32 v179, v251, v179
    v_cvt_pk_bf16_f32 v52, v172, v173
    v_cvt_pk_bf16_f32 v53, v174, v175
    v_cvt_pk_bf16_f32 v54, v176, v177
    v_cvt_pk_bf16_f32 v55, v178, v179
    s_waitcnt lgkmcnt(0)
    v_cmp_gt_u32 vcc, s78, v70
    s_nop 0
    s_mov_b32 s79, vcc_lo
    s_waitcnt vmcnt(5)
    s_barrier
    ds_read_b128 v[196:199], v88 offset:192
    ds_read_b64_tr_b16 v[140:141], v87 offset:40960
    ds_read_b64_tr_b16 v[142:143], v87 offset:41984
    ds_read_b64_tr_b16 v[144:145], v87 offset:49152
    s_add_u32 m0, s34, 43520
    s_nop 0
    buffer_load_dwordx4 v153, s[20:23], 0 offen nt lds
    ds_read_b64_tr_b16 v[146:147], v87 offset:50176
    ds_read_b64_tr_b16 v[116:117], v85 offset:32768
    ds_read_b64_tr_b16 v[118:119], v85 offset:33792
    ds_read_b64_tr_b16 v[124:125], v85 offset:49152
    s_add_u32 m0, s34, 52224
    s_nop 0
    buffer_load_dwordx4 v154, s[20:23], 0 offen nt lds
    ds_read_b64_tr_b16 v[126:127], v85 offset:50176
    ds_read_b64_tr_b16 v[132:133], v85 offset:57344
    ds_read_b64_tr_b16 v[134:135], v85 offset:58368
    ds_read_b64_tr_b16 v[120:121], v85 offset:36864
    ds_read_b64_tr_b16 v[122:123], v85 offset:37888
    ds_read_b64_tr_b16 v[128:129], v85 offset:53248
    ds_read_b64_tr_b16 v[130:131], v85 offset:54272
    s_waitcnt lgkmcnt(11)
    ds_read_b64_tr_b16 v[136:137], v85 offset:61440
    ds_read_b64_tr_b16 v[138:139], v85 offset:62464
    s_waitcnt lgkmcnt(12)
    v_mfma_f32_16x16x32_bf16 v[208:211], v[140:143], v[196:199], v[208:211]
    v_mfma_f32_16x16x32_bf16 v[212:215], v[144:147], v[196:199], v[212:215]
    s_waitcnt lgkmcnt(10)
    v_mfma_f32_32x32x16_bf16 v[164:179], v[200:203], v[116:119], 0
    v_and_b32 v180, v194, v204
    v_and_b32 v181, v194, v205
    v_and_b32 v182, v194, v206
    v_and_b32 v183, v194, v207
    v_mul_f32 v216, v251, v216
    v_mul_f32 v217, v251, v217
    v_mul_f32 v218, v251, v218
    v_mul_f32 v219, v251, v219
    v_mul_f32 v220, v251, v220
    s_waitcnt lgkmcnt(8)
    v_mfma_f32_32x32x16_bf16 v[164:179], v[200:203], v[124:127], v[164:179]
    v_mul_f32 v221, v251, v221
    v_mul_f32 v222, v251, v222
    v_mul_f32 v223, v251, v223
    v_cvt_pk_bf16_f32 v24, v216, v217
    v_cvt_pk_bf16_f32 v25, v218, v219
    v_cvt_pk_bf16_f32 v26, v220, v221
    v_cvt_pk_bf16_f32 v27, v222, v223
    v_mul_f32 v224, v251, v224
    v_mul_f32 v225, v251, v225
    v_mul_f32 v226, v251, v226
    s_waitcnt lgkmcnt(6)
    v_mfma_f32_32x32x16_bf16 v[164:179], v[180:183], v[132:135], v[164:179]
    v_mul_f32 v227, v251, v227
    v_mul_f32 v228, v251, v228
    v_mul_f32 v229, v251, v229
    v_mul_f32 v230, v251, v230
    v_mul_f32 v231, v251, v231
    v_cvt_pk_bf16_f32 v56, v224, v225
    v_cvt_pk_bf16_f32 v57, v226, v227
    v_cvt_pk_bf16_f32 v58, v228, v229
    v_cvt_pk_bf16_f32 v59, v230, v231
    s_waitcnt lgkmcnt(4)
    v_mfma_f32_32x32x16_bf16 v[216:231], v[200:203], v[120:123], 0
    v_and_b32 v184, v195, v204
    v_and_b32 v185, v195, v205
    v_and_b32 v186, v195, v206
    v_and_b32 v187, v195, v207
    v_sub_f32 v208, v208, v212
    v_sub_f32 v209, v209, v213
    v_sub_f32 v210, v210, v214
    v_sub_f32 v211, v211, v215
    v_fma_f32 v208, v208, v251, v96
    v_fma_f32 v209, v209, v251, v97
    v_fma_f32 v210, v210, v251, v98
    v_fma_f32 v211, v211, v251, v99
    v_mul_f32 v164, v251, v164
    v_mul_f32 v165, v251, v165
    v_mul_f32 v166, v251, v166
    v_mul_f32 v167, v251, v167
    v_mul_f32 v168, v251, v168
    v_mul_f32 v169, v251, v169
    s_waitcnt lgkmcnt(2)
    v_mfma_f32_32x32x16_bf16 v[216:231], v[200:203], v[128:131], v[216:231]
    v_mul_f32 v170, v251, v170
    v_mul_f32 v171, v251, v171
    v_cvt_pk_bf16_f32 v28, v164, v165
    v_cvt_pk_bf16_f32 v29, v166, v167
    v_cvt_pk_bf16_f32 v30, v168, v169
    v_cvt_pk_bf16_f32 v31, v170, v171
    v_mul_f32 v172, v251, v172
    v_mul_f32 v173, v251, v173
    v_mul_f32 v174, v251, v174
    s_waitcnt lgkmcnt(0)
    v_mfma_f32_32x32x16_bf16 v[216:231], v[184:187], v[136:139], v[216:231]
    v_mul_f32 v175, v251, v175
    v_mul_f32 v176, v251, v176
    v_mul_f32 v177, v251, v177
    v_mul_f32 v178, v251, v178
    v_mul_f32 v179, v251, v179
    v_cvt_pk_bf16_f32 v60, v172, v173
    v_cvt_pk_bf16_f32 v61, v174, v175
    v_cvt_pk_bf16_f32 v62, v176, v177
    v_cvt_pk_bf16_f32 v63, v178, v179
    s_mov_b32 exec_lo, 0x000f000f
    s_mov_b32 exec_hi, 0x000f000f
    ds_write_b128 v93, v[208:211]
    s_mov_b64 exec, -1
    s_waitcnt vmcnt(3)
    s_waitcnt lgkmcnt(0)
    s_barrier
    s_cmp_lg_u32 s79, 0
    s_cbranch_scc1 L_slow
    ds_read_b128 v[68:71], v249 offset:0
    ds_read_b128 v[72:75], v249 offset:32
    ds_read_b128 v[76:79], v249 offset:64
    ds_read_b128 v[80:83], v249 offset:96
    ds_read_b128 v[116:119], v232 offset:0
    ds_read_b128 v[120:123], v234 offset:0
    ds_read_b128 v[124:127], v232 offset:64
    ds_read_b128 v[128:131], v234 offset:64
    ds_read_b128 v[132:135], v232 offset:128
    ds_read_b128 v[136:139], v234 offset:128
    ds_read_b128 v[140:143], v232 offset:192
    ds_read_b128 v[144:147], v234 offset:192
    s_waitcnt lgkmcnt(7)
    v_mfma_f32_32x32x16_bf16 v[148:163], v[4:7], v[116:119], v[68:83]
    v_mul_f32 v216, v251, v216
    v_mul_f32 v217, v251, v217
    v_mul_f32 v218, v251, v218
    v_mul_f32 v219, v251, v219
    s_waitcnt lgkmcnt(6)
    v_mfma_f32_32x32x16_bf16 v[148:163], v[8:11], v[120:123], v[148:163]
    ds_read_b128 v[116:119], v232 offset:17408
    v_mul_f32 v220, v251, v220
    v_mul_f32 v221, v251, v221
    v_mul_f32 v222, v251, v222
    v_mul_f32 v223, v251, v223
    v_cvt_pk_bf16_f32 v32, v216, v217
    s_waitcnt lgkmcnt(6)
    v_mfma_f32_32x32x16_bf16 v[148:163], v[12:15], v[124:127], v[148:163]
    ds_read_b128 v[120:123], v234 offset:17408
    ds_read_b128 v[84:87], v249 offset:512
    v_cvt_pk_bf16_f32 v33, v218, v219
    v_cvt_pk_bf16_f32 v34, v220, v221
    v_cvt_pk_bf16_f32 v35, v222, v223
    v_mul_f32 v224, v251, v224
    v_mul_f32 v225, v251, v225
    s_waitcnt lgkmcnt(7)
    v_mfma_f32_32x32x16_bf16 v[148:163], v[16:19], v[128:131], v[148:163]
    ds_read_b128 v[124:127], v232 offset:17472
    ds_read_b128 v[88:91], v249 offset:544
    v_mul_f32 v226, v251, v226
    v_mul_f32 v227, v251, v227
    v_mul_f32 v228, v251, v228
    v_mul_f32 v229, v251, v229
    v_mul_f32 v230, v251, v230
    s_waitcnt lgkmcnt(8)
    v_mfma_f32_32x32x16_bf16 v[148:163], v[20:23], v[132:135], v[148:163]
    ds_read_b128 v[128:131], v234 offset:17472
    ds_read_b128 v[92:95], v249 offset:576
    v_mul_f32 v231, v251, v231
    v_cvt_pk_bf16_f32 v64, v224, v225
    v_cvt_pk_bf16_f32 v65, v226, v227
    v_cvt_pk_bf16_f32 v66, v228, v229
    v_cvt_pk_bf16_f32 v67, v230, v231
    s_waitcnt lgkmcnt(9)
    v_mfma_f32_32x32x16_bf16 v[148:163], v[24:27], v[136:139], v[148:163]
    ds_read_b128 v[132:135], v232 offset:17536
    ds_read_b128 v[96:99], v249 offset:608
    v_mov_b32 v251, 0x2b800000
    v_mov_b32 v250, 0
    v_mov_b32 v217, s78
    v_mov_b32 v208, 0
    v_mov_b32 v209, 0
    s_waitcnt lgkmcnt(10)
    v_mfma_f32_32x32x16_bf16 v[148:163], v[28:31], v[140:143], v[148:163]
    ds_read_b128 v[136:139], v234 offset:17536
    v_mov_b32 v210, 0
    v_mov_b32 v211, 0
    v_mov_b32 v212, 0
    v_mov_b32 v213, 0
    v_mov_b32 v214, 0
    s_waitcnt lgkmcnt(10)
    v_mfma_f32_32x32x16_bf16 v[148:163], v[32:35], v[144:147], v[148:163]
    ds_read_b128 v[140:143], v232 offset:17600
    v_mov_b32 v215, 0
    ds_read_b128 v[144:147], v234 offset:17600
    s_waitcnt lgkmcnt(3)
    v_mfma_f32_32x32x16_bf16 v[164:179], v[36:39], v[116:119], v[84:99]
    v_mfma_f32_32x32x16_bf16 v[164:179], v[40:43], v[120:123], v[164:179]
    s_nop 5
    v_exp_f32_e64 v148, v148 clamp
    v_exp_f32_e64 v149, v149 clamp
    v_exp_f32_e64 v150, v150 clamp
    v_mfma_f32_32x32x16_bf16 v[164:179], v[44:47], v[124:127], v[164:179]
    v_exp_f32_e64 v151, v151 clamp
    v_exp_f32_e64 v152, v152 clamp
    v_exp_f32_e64 v153, v153 clamp
    v_mfma_f32_32x32x16_bf16 v[164:179], v[48:51], v[128:131], v[164:179]
    v_exp_f32_e64 v154, v154 clamp
    v_exp_f32_e64 v155, v155 clamp
    v_exp_f32_e64 v156, v156 clamp
    s_waitcnt lgkmcnt(2)
    v_mfma_f32_32x32x16_bf16 v[164:179], v[52:55], v[132:135], v[164:179]
    v_exp_f32_e64 v157, v157 clamp
    v_exp_f32_e64 v158, v158 clamp
    v_exp_f32_e64 v159, v159 clamp
    v_mfma_f32_32x32x16_bf16 v[164:179], v[56:59], v[136:139], v[164:179]
    v_exp_f32_e64 v160, v160 clamp
    v_exp_f32_e64 v161, v161 clamp
    v_exp_f32_e64 v162, v162 clamp
    s_waitcnt lgkmcnt(0)
    v_mfma_f32_32x32x16_bf16 v[164:179], v[60:63], v[140:143], v[164:179]
    v_exp_f32_e64 v163, v163 clamp
    v_mfma_f32_32x32x16_bf16 v[164:179], v[64:67], v[144:147], v[164:179]
    ds_read_u16 v0, v253 offset:2432
    ds_read_u16 v1, v253 offset:2368
    ds_read_u16 v2, v253 offset:768
    ds_read_u16 v3, v253 offset:704
    s_waitcnt lgkmcnt(0)
    v_lshl_add_u32 v0, v0, 8, v254
    v_lshl_add_u32 v1, v1, 8, v254
    v_lshl_add_u32 v2, v2, 8, v254
    v_lshl_add_u32 v3, v3, 8, v254
    s_add_u32 m0, s34, 60928
    s_nop 0
    buffer_load_dwordx4 v0, s[20:23], 0 offen nt lds
    s_add_u32 m0, s34, 56576
    s_nop 0
    buffer_load_dwordx4 v1, s[20:23], 0 offen nt lds
    s_add_u32 m0, s34, 69632
    s_nop 0
    buffer_load_dwordx4 v2, s[20:23], 0 offen nt lds
    s_add_u32 m0, s34, 65280
    s_nop 0
    buffer_load_dwordx4 v3, s[20:23], 0 offen nt lds
    s_waitcnt vmcnt(5)
    s_barrier
    ds_read_b128 v[116:119], v232 offset:34816
    ds_read_b128 v[120:123], v234 offset:34816
    ds_read_b128 v[124:127], v232 offset:34880
    ds_read_b128 v[128:131], v234 offset:34880
    ds_read_b128 v[132:135], v232 offset:34944
    ds_read_b128 v[136:139], v234 offset:34944
    ds_read_b128 v[140:143], v232 offset:35008
    ds_read_b128 v[144:147], v234 offset:35008
    v_add_f32 v148, v251, v148
    v_add_f32 v149, v251, v149
    v_add_f32 v150, v251, v150
    v_add_f32 v151, v251, v151
    v_add_f32 v152, v251, v152
    v_add_f32 v153, v251, v153
    v_add_f32 v154, v251, v154
    v_add_f32 v155, v251, v155
    v_add_f32 v156, v251, v156
    v_add_f32 v157, v251, v157
    v_add_f32 v158, v251, v158
    v_add_f32 v159, v251, v159
    v_add_f32 v160, v251, v160
    v_add_f32 v161, v251, v161
    v_add_f32 v162, v251, v162
    v_add_f32 v163, v251, v163
    v_mul_f32 v180, v148, v149
    v_mul_f32 v181, v150, v151
    v_mul_f32 v182, v152, v153
    v_mul_f32 v183, v154, v155
    v_mul_f32 v184, v156, v157
    v_mul_f32 v185, v158, v159
    v_mul_f32 v186, v160, v161
    v_mul_f32 v187, v162, v163
    v_mul_f32 v188, v148, v101
    v_mul_f32 v189, v150, v103
    v_mul_f32 v190, v152, v105
    v_mul_f32 v191, v154, v107
    v_mul_f32 v192, v156, v109
    v_mul_f32 v193, v158, v111
    v_mul_f32 v194, v160, v113
    v_mul_f32 v195, v162, v115
    v_fmac_f32 v188, v149, v100
    v_fmac_f32 v189, v151, v102
    v_fmac_f32 v190, v153, v104
    v_fmac_f32 v191, v155, v106
    v_fmac_f32 v192, v157, v108
    v_fmac_f32 v193, v159, v110
    v_fmac_f32 v194, v161, v112
    v_fmac_f32 v195, v163, v114
    s_waitcnt lgkmcnt(6)
    v_mfma_f32_32x32x16_bf16 v[148:163], v[4:7], v[116:119], v[68:83]
    v_rcp_f32 v180, v180
    v_rcp_f32 v181, v181
    v_rcp_f32 v182, v182
    v_mfma_f32_32x32x16_bf16 v[148:163], v[8:11], v[120:123], v[148:163]
    v_rcp_f32 v183, v183
    v_rcp_f32 v184, v184
    v_rcp_f32 v185, v185
    s_waitcnt lgkmcnt(4)
    v_mfma_f32_32x32x16_bf16 v[148:163], v[12:15], v[124:127], v[148:163]
    v_rcp_f32 v186, v186
    v_rcp_f32 v187, v187
    v_exp_f32_e64 v164, v164 clamp
    v_mfma_f32_32x32x16_bf16 v[148:163], v[16:19], v[128:131], v[148:163]
    v_exp_f32_e64 v165, v165 clamp
    v_exp_f32_e64 v166, v166 clamp
    v_exp_f32_e64 v167, v167 clamp
    s_waitcnt lgkmcnt(2)
    v_mfma_f32_32x32x16_bf16 v[148:163], v[20:23], v[132:135], v[148:163]
    v_exp_f32_e64 v168, v168 clamp
    v_exp_f32_e64 v169, v169 clamp
    v_exp_f32_e64 v170, v170 clamp
    v_mfma_f32_32x32x16_bf16 v[148:163], v[24:27], v[136:139], v[148:163]
    v_exp_f32_e64 v171, v171 clamp
    v_exp_f32_e64 v172, v172 clamp
    v_exp_f32_e64 v173, v173 clamp
    s_waitcnt lgkmcnt(0)
    v_mfma_f32_32x32x16_bf16 v[148:163], v[28:31], v[140:143], v[148:163]
    v_exp_f32_e64 v174, v174 clamp
    v_exp_f32_e64 v175, v175 clamp
    v_exp_f32_e64 v176, v176 clamp
    v_mfma_f32_32x32x16_bf16 v[148:163], v[32:35], v[144:147], v[148:163]
    v_exp_f32_e64 v177, v177 clamp
    v_exp_f32_e64 v178, v178 clamp
    v_exp_f32_e64 v179, v179 clamp
    ds_read_u16 v0, v253 offset:2560
    ds_read_u16 v1, v253 offset:2496
    ds_read_u16 v2, v253 offset:1408
    ds_read_u16 v3, v253 offset:1344
    ds_read_u16_d16_hi v250, v246 offset:386
    s_waitcnt lgkmcnt(1)
    v_lshl_add_u32 v0, v0, 8, v254
    v_lshl_add_u32 v1, v1, 8, v254
    v_lshl_add_u32 v2, v2, 8, v254
    v_lshl_add_u32 v3, v3, 8, v254
    s_add_u32 m0, s34, 78336
    s_nop 0
    buffer_load_dwordx4 v0, s[20:23], 0 offen nt lds
    s_add_u32 m0, s34, 73984
    s_nop 0
    buffer_load_dwordx4 v1, s[20:23], 0 offen nt lds
    s_add_u32 m0, s34, 87040
    s_nop 0
    buffer_load_dwordx4 v2, s[20:23], 0 offen nt lds
    s_add_u32 m0, s34, 82688
    s_nop 0
    buffer_load_dwordx4 v3, s[20:23], 0 offen nt lds
    s_waitcnt vmcnt(6)
    s_waitcnt lgkmcnt(0)
    s_barrier
    ds_read_b128 v[116:119], v232 offset:52224
    ds_read_b128 v[120:123], v234 offset:52224
    ds_read_b128 v[124:127], v232 offset:52288
    ds_read_b128 v[128:131], v234 offset:52288
    ds_read_b128 v[132:135], v232 offset:52352
    ds_read_b128 v[136:139], v234 offset:52352
    ds_read_b128 v[140:143], v232 offset:52416
    ds_read_b128 v[144:147], v234 offset:52416
    v_add_f32 v164, v251, v164
    v_fma_f32 v249, v188, v180, v248
    v_add_f32 v165, v251, v165
    v_add_f32 v166, v251, v166
    v_fmac_f32 v249, v189, v181
    v_add_f32 v167, v251, v167
    v_add_f32 v168, v251, v168
    v_fmac_f32 v249, v190, v182
    v_add_f32 v169, v251, v169
    v_add_f32 v170, v251, v170
    v_fmac_f32 v249, v191, v183
    v_add_f32 v171, v251, v171
    v_add_f32 v172, v251, v172
    v_fmac_f32 v249, v192, v184
    v_add_f32 v173, v251, v173
    v_add_f32 v174, v251, v174
    v_fmac_f32 v249, v193, v185
    v_add_f32 v175, v251, v175
    v_add_f32 v176, v251, v176
    v_fmac_f32 v249, v194, v186
    v_add_f32 v177, v251, v177
    v_add_f32 v178, v251, v178
    v_fmac_f32 v249, v195, v187
    v_add_f32 v179, v251, v179
    v_mul_f32 v252, v249, v250
    v_mul_f32 v180, v164, v165
    v_mul_f32 v181, v166, v167
    v_add_u32 v252, v217, v252
    v_mul_f32 v182, v168, v169
    v_mul_f32 v183, v170, v171
    v_mul_f32 v184, v172, v173
    v_mul_f32 v185, v174, v175
    v_mul_f32 v186, v176, v177
    v_mul_f32 v187, v178, v179
    v_mul_f32 v188, v164, v101
    v_mul_f32 v189, v166, v103
    v_mul_f32 v190, v168, v105
    v_mul_f32 v191, v170, v107
    v_mul_f32 v192, v172, v109
    v_mul_f32 v193, v174, v111
    v_mul_f32 v194, v176, v113
    v_mul_f32 v195, v178, v115
    v_fmac_f32 v188, v165, v100
    v_fmac_f32 v189, v167, v102
    v_fmac_f32 v190, v169, v104
    v_fmac_f32 v191, v171, v106
    v_fmac_f32 v192, v173, v108
    v_fmac_f32 v193, v175, v110
    v_fmac_f32 v194, v177, v112
    v_fmac_f32 v195, v179, v114
    s_waitcnt lgkmcnt(6)
    v_mfma_f32_32x32x16_bf16 v[164:179], v[4:7], v[116:119], v[68:83]
    v_rcp_f32 v180, v180
    v_rcp_f32 v181, v181
    v_rcp_f32 v182, v182
    v_mfma_f32_32x32x16_bf16 v[164:179], v[8:11], v[120:123], v[164:179]
    v_rcp_f32 v183, v183
    v_rcp_f32 v184, v184
    v_rcp_f32 v185, v185
    s_waitcnt lgkmcnt(4)
    v_mfma_f32_32x32x16_bf16 v[164:179], v[12:15], v[124:127], v[164:179]
    v_rcp_f32 v186, v186
    v_rcp_f32 v187, v187
    v_exp_f32_e64 v148, v148 clamp
    v_mfma_f32_32x32x16_bf16 v[164:179], v[16:19], v[128:131], v[164:179]
    v_exp_f32_e64 v149, v149 clamp
    v_exp_f32_e64 v150, v150 clamp
    v_exp_f32_e64 v151, v151 clamp
    s_waitcnt lgkmcnt(2)
    v_mfma_f32_32x32x16_bf16 v[164:179], v[20:23], v[132:135], v[164:179]
    v_exp_f32_e64 v152, v152 clamp
    v_exp_f32_e64 v153, v153 clamp
    v_exp_f32_e64 v154, v154 clamp
    v_mfma_f32_32x32x16_bf16 v[164:179], v[24:27], v[136:139], v[164:179]
    v_exp_f32_e64 v155, v155 clamp
    v_exp_f32_e64 v156, v156 clamp
    v_exp_f32_e64 v157, v157 clamp
    s_waitcnt lgkmcnt(0)
    v_mfma_f32_32x32x16_bf16 v[164:179], v[28:31], v[140:143], v[164:179]
    v_exp_f32_e64 v158, v158 clamp
    v_exp_f32_e64 v159, v159 clamp
    v_exp_f32_e64 v160, v160 clamp
    v_mfma_f32_32x32x16_bf16 v[164:179], v[32:35], v[144:147], v[164:179]
    v_exp_f32_e64 v161, v161 clamp
    v_exp_f32_e64 v162, v162 clamp
    v_exp_f32_e64 v163, v163 clamp
    ds_read_u16 v0, v253 offset:3200
    ds_read_u16 v1, v253 offset:3136
    ds_read_u16 v2, v253 offset:1536
    ds_read_u16 v3, v253 offset:1472
    ds_write_b16_d16_hi v244, v252 offset:0
    ds_read_u16_d16_hi v250, v246 offset:1282
    s_waitcnt lgkmcnt(2)
    v_lshl_add_u32 v0, v0, 8, v254
    v_lshl_add_u32 v1, v1, 8, v254
    v_lshl_add_u32 v2, v2, 8, v254
    v_lshl_add_u32 v3, v3, 8, v254
    s_add_u32 m0, s34, 95744
    s_nop 0
    buffer_load_dwordx4 v0, s[20:23], 0 offen nt lds
    s_add_u32 m0, s34, 91392
    s_nop 0
    buffer_load_dwordx4 v1, s[20:23], 0 offen nt lds
    s_add_u32 m0, s34, 104448
    s_nop 0
    buffer_load_dwordx4 v2, s[20:23], 0 offen nt lds
    s_add_u32 m0, s34, 100096
    s_nop 0
    buffer_load_dwordx4 v3, s[20:23], 0 offen nt lds
    s_waitcnt vmcnt(6)
    s_waitcnt lgkmcnt(0)
    s_barrier
    ds_read_b128 v[116:119], v233 offset:0
    ds_read_b128 v[120:123], v235 offset:0
    ds_read_b128 v[124:127], v233 offset:64
    ds_read_b128 v[128:131], v235 offset:64
    ds_read_b128 v[132:135], v233 offset:128
    ds_read_b128 v[136:139], v235 offset:128
    ds_read_b128 v[140:143], v233 offset:192
    ds_read_b128 v[144:147], v235 offset:192
    v_add_f32 v148, v251, v148
    v_fma_f32 v249, v188, v180, v248
    v_add_f32 v149, v251, v149
    v_add_f32 v150, v251, v150
    v_fmac_f32 v249, v189, v181
    v_add_f32 v151, v251, v151
    v_add_f32 v152, v251, v152
    v_fmac_f32 v249, v190, v182
    v_add_f32 v153, v251, v153
    v_add_f32 v154, v251, v154
    v_fmac_f32 v249, v191, v183
    v_add_f32 v155, v251, v155
    v_add_f32 v156, v251, v156
    v_fmac_f32 v249, v192, v184
    v_add_f32 v157, v251, v157
    v_add_f32 v158, v251, v158
    v_fmac_f32 v249, v193, v185
    v_add_f32 v159, v251, v159
    v_add_f32 v160, v251, v160
    v_fmac_f32 v249, v194, v186
    v_add_f32 v161, v251, v161
    v_add_f32 v162, v251, v162
    v_fmac_f32 v249, v195, v187
    v_add_f32 v163, v251, v163
    v_mul_f32 v252, v249, v250
    v_mul_f32 v180, v148, v149
    v_mul_f32 v181, v150, v151
    v_add_u32 v252, v217, v252
    v_mul_f32 v182, v152, v153
    v_mul_f32 v183, v154, v155
    v_mul_f32 v184, v156, v157
    v_mul_f32 v185, v158, v159
    v_mul_f32 v186, v160, v161
    v_mul_f32 v187, v162, v163
    v_mul_f32 v188, v148, v101
    v_mul_f32 v189, v150, v103
    v_mul_f32 v190, v152, v105
    v_mul_f32 v191, v154, v107
    v_mul_f32 v192, v156, v109
    v_mul_f32 v193, v158, v111
    v_mul_f32 v194, v160, v113
    v_mul_f32 v195, v162, v115
    v_fmac_f32 v188, v149, v100
    v_fmac_f32 v189, v151, v102
    v_fmac_f32 v190, v153, v104
    v_fmac_f32 v191, v155, v106
    v_fmac_f32 v192, v157, v108
    v_fmac_f32 v193, v159, v110
    v_fmac_f32 v194, v161, v112
    v_fmac_f32 v195, v163, v114
    s_waitcnt lgkmcnt(6)
    v_mfma_f32_32x32x16_bf16 v[148:163], v[4:7], v[116:119], v[68:83]
    v_rcp_f32 v180, v180
    v_rcp_f32 v181, v181
    v_rcp_f32 v182, v182
    v_mfma_f32_32x32x16_bf16 v[148:163], v[8:11], v[120:123], v[148:163]
    v_rcp_f32 v183, v183
    v_rcp_f32 v184, v184
    v_rcp_f32 v185, v185
    s_waitcnt lgkmcnt(4)
    v_mfma_f32_32x32x16_bf16 v[148:163], v[12:15], v[124:127], v[148:163]
    v_rcp_f32 v186, v186
    v_rcp_f32 v187, v187
    v_exp_f32_e64 v164, v164 clamp
    v_mfma_f32_32x32x16_bf16 v[148:163], v[16:19], v[128:131], v[148:163]
    v_exp_f32_e64 v165, v165 clamp
    v_exp_f32_e64 v166, v166 clamp
    v_exp_f32_e64 v167, v167 clamp
    s_waitcnt lgkmcnt(2)
    v_mfma_f32_32x32x16_bf16 v[148:163], v[20:23], v[132:135], v[148:163]
    v_exp_f32_e64 v168, v168 clamp
    v_exp_f32_e64 v169, v169 clamp
    v_exp_f32_e64 v170, v170 clamp
    v_mfma_f32_32x32x16_bf16 v[148:163], v[24:27], v[136:139], v[148:163]
    v_exp_f32_e64 v171, v171 clamp
    v_exp_f32_e64 v172, v172 clamp
    v_exp_f32_e64 v173, v173 clamp
    s_waitcnt lgkmcnt(0)
    v_mfma_f32_32x32x16_bf16 v[148:163], v[28:31], v[140:143], v[148:163]
    v_exp_f32_e64 v174, v174 clamp
    v_exp_f32_e64 v175, v175 clamp
    v_exp_f32_e64 v176, v176 clamp
    v_mfma_f32_32x32x16_bf16 v[148:163], v[32:35], v[144:147], v[148:163]
    v_exp_f32_e64 v177, v177 clamp
    v_exp_f32_e64 v178, v178 clamp
    v_exp_f32_e64 v179, v179 clamp
    ds_read_u16 v0, v253 offset:3328
    ds_read_u16 v1, v253 offset:3264
    ds_read_u16 v2, v253 offset:1664
    ds_read_u16 v3, v253 offset:1600
    ds_write_b16_d16_hi v247, v252 offset:1024
    ds_read_u16_d16_hi v250, v246 offset:514
    ds_read_b128 v[196:199], v245 offset:0
    ds_read_b64_tr_b16 v[200:201], v236 offset:0
    ds_read_b64_tr_b16 v[202:203], v237 offset:256
    ds_read_b64_tr_b16 v[204:205], v238 offset:0
    ds_read_b64_tr_b16 v[206:207], v239 offset:256
    s_waitcnt lgkmcnt(7)
    v_lshl_add_u32 v0, v0, 8, v254
    v_lshl_add_u32 v1, v1, 8, v254
    v_lshl_add_u32 v2, v2, 8, v254
    v_lshl_add_u32 v3, v3, 8, v254
    s_add_u32 m0, s34, 113152
    s_nop 0
    buffer_load_dwordx4 v0, s[20:23], 0 offen nt lds
    s_add_u32 m0, s34, 108800
    s_nop 0
    buffer_load_dwordx4 v1, s[20:23], 0 offen nt lds
    s_add_u32 m0, s34, 121856
    s_nop 0
    buffer_load_dwordx4 v2, s[20:23], 0 offen nt lds
    s_add_u32 m0, s34, 117504
    s_nop 0
    buffer_load_dwordx4 v3, s[20:23], 0 offen nt lds
    s_waitcnt vmcnt(6)
    s_waitcnt lgkmcnt(5)
    s_barrier
    ds_read_b128 v[116:119], v233 offset:17408
    ds_read_b128 v[120:123], v235 offset:17408
    ds_read_b128 v[124:127], v233 offset:17472
    ds_read_b128 v[128:131], v235 offset:17472
    ds_read_b128 v[132:135], v233 offset:17536
    ds_read_b128 v[136:139], v235 offset:17536
    ds_read_b128 v[140:143], v233 offset:17600
    ds_read_b128 v[144:147], v235 offset:17600
    v_add_f32 v164, v251, v164
    v_fma_f32 v249, v188, v180, v248
    v_add_f32 v165, v251, v165
    v_add_f32 v166, v251, v166
    v_fmac_f32 v249, v189, v181
    v_add_f32 v167, v251, v167
    v_add_f32 v168, v251, v168
    v_fmac_f32 v249, v190, v182
    v_add_f32 v169, v251, v169
    v_add_f32 v170, v251, v170
    v_fmac_f32 v249, v191, v183
    v_add_f32 v171, v251, v171
    v_add_f32 v172, v251, v172
    v_fmac_f32 v249, v192, v184
    v_add_f32 v173, v251, v173
    v_add_f32 v174, v251, v174
    v_fmac_f32 v249, v193, v185
    v_add_f32 v175, v251, v175
    v_add_f32 v176, v251, v176
    v_fmac_f32 v249, v194, v186
    v_add_f32 v177, v251, v177
    v_add_f32 v178, v251, v178
    v_fmac_f32 v249, v195, v187
    v_add_f32 v179, v251, v179
    v_mul_f32 v252, v249, v250
    v_mul_f32 v180, v164, v165
    v_mul_f32 v181, v166, v167
    v_add_u32 v252, v217, v252
    v_mul_f32 v182, v168, v169
    v_mul_f32 v183, v170, v171
    v_mul_f32 v184, v172, v173
    v_mul_f32 v185, v174, v175
    v_mul_f32 v186, v176, v177
    v_mul_f32 v187, v178, v179
    v_mul_f32 v188, v164, v101
    v_mul_f32 v189, v166, v103
    v_mul_f32 v190, v168, v105
    v_mul_f32 v191, v170, v107
    v_mul_f32 v192, v172, v109
    v_mul_f32 v193, v174, v111
    v_mul_f32 v194, v176, v113
    v_mul_f32 v195, v178, v115
    v_fmac_f32 v188, v165, v100
    v_fmac_f32 v189, v167, v102
    v_fmac_f32 v190, v169, v104
    v_fmac_f32 v191, v171, v106
    v_fmac_f32 v192, v173, v108
    v_fmac_f32 v193, v175, v110
    v_fmac_f32 v194, v177, v112
    v_fmac_f32 v195, v179, v114
    v_rcp_f32 v180, v180
    v_rcp_f32 v181, v181
    s_waitcnt lgkmcnt(6)
    v_mfma_f32_32x32x16_bf16 v[164:179], v[36:39], v[116:119], v[84:99]
    v_rcp_f32 v182, v182
    v_rcp_f32 v183, v183
    v_rcp_f32 v184, v184
    v_mfma_f32_32x32x16_bf16 v[164:179], v[40:43], v[120:123], v[164:179]
    v_rcp_f32 v185, v185
    v_rcp_f32 v186, v186
    v_rcp_f32 v187, v187
    s_waitcnt lgkmcnt(4)
    v_mfma_f32_32x32x16_bf16 v[164:179], v[44:47], v[124:127], v[164:179]
    v_exp_f32_e64 v148, v148 clamp
    v_exp_f32_e64 v149, v149 clamp
    v_exp_f32_e64 v150, v150 clamp
    v_mfma_f32_32x32x16_bf16 v[164:179], v[48:51], v[128:131], v[164:179]
    v_exp_f32_e64 v151, v151 clamp
    v_exp_f32_e64 v152, v152 clamp
    v_exp_f32_e64 v153, v153 clamp
    s_waitcnt lgkmcnt(2)
    v_mfma_f32_32x32x16_bf16 v[164:179], v[52:55], v[132:135], v[164:179]
    v_exp_f32_e64 v154, v154 clamp
    v_exp_f32_e64 v155, v155 clamp
    v_exp_f32_e64 v156, v156 clamp
    v_mfma_f32_32x32x16_bf16 v[164:179], v[56:59], v[136:139], v[164:179]
    v_exp_f32_e64 v157, v157 clamp
    v_exp_f32_e64 v158, v158 clamp
    v_exp_f32_e64 v159, v159 clamp
    v_mfma_f32_16x16x32_bf16 v[208:211], v[196:199], v[200:203], v[208:211]
    v_exp_f32_e64 v160, v160 clamp
    v_mfma_f32_16x16x32_bf16 v[212:215], v[196:199], v[204:207], v[212:215]
    v_exp_f32_e64 v161, v161 clamp
    s_waitcnt lgkmcnt(0)
    v_mfma_f32_32x32x16_bf16 v[164:179], v[60:63], v[140:143], v[164:179]
    v_exp_f32_e64 v162, v162 clamp
    v_exp_f32_e64 v163, v163 clamp
    v_mfma_f32_32x32x16_bf16 v[164:179], v[64:67], v[144:147], v[164:179]
    ds_read_u16 v0, v253 offset:3456
    ds_read_u16 v1, v253 offset:3392
    ds_write_b16_d16_hi v244, v252 offset:2560
    ds_read_u16_d16_hi v250, v246 offset:642
    ds_read_b128 v[196:199], v245 offset:512
    ds_read_b64_tr_b16 v[200:201], v236 offset:17408
    ds_read_b64_tr_b16 v[202:203], v237 offset:17664
    ds_read_b64_tr_b16 v[204:205], v238 offset:17408
    ds_read_b64_tr_b16 v[206:207], v239 offset:17664
    s_waitcnt lgkmcnt(7)
    v_lshl_add_u32 v0, v0, 8, v254
    v_lshl_add_u32 v1, v1, 8, v254
    s_add_u32 m0, s34, 130560
    s_nop 0
    buffer_load_dwordx4 v0, s[20:23], 0 offen nt lds
    s_add_u32 m0, s34, 126208
    s_nop 0
    buffer_load_dwordx4 v1, s[20:23], 0 offen nt lds
    s_waitcnt vmcnt(4)
    s_waitcnt lgkmcnt(5)
    s_barrier
    ds_read_b128 v[116:119], v233 offset:34816
    ds_read_b128 v[120:123], v235 offset:34816
    ds_read_b128 v[124:127], v233 offset:34880
    ds_read_b128 v[128:131], v235 offset:34880
    ds_read_b128 v[132:135], v233 offset:34944
    ds_read_b128 v[136:139], v235 offset:34944
    ds_read_b128 v[140:143], v233 offset:35008
    ds_read_b128 v[144:147], v235 offset:35008
    v_add_f32 v148, v251, v148
    v_fma_f32 v249, v188, v180, v248
    v_add_f32 v149, v251, v149
    v_add_f32 v150, v251, v150
    v_fmac_f32 v249, v189, v181
    v_add_f32 v151, v251, v151
    v_add_f32 v152, v251, v152
    v_fmac_f32 v249, v190, v182
    v_add_f32 v153, v251, v153
    v_add_f32 v154, v251, v154
    v_fmac_f32 v249, v191, v183
    v_add_f32 v155, v251, v155
    v_add_f32 v156, v251, v156
    v_fmac_f32 v249, v192, v184
    v_add_f32 v157, v251, v157
    v_add_f32 v158, v251, v158
    v_fmac_f32 v249, v193, v185
    v_add_f32 v159, v251, v159
    v_add_f32 v160, v251, v160
    v_fmac_f32 v249, v194, v186
    v_add_f32 v161, v251, v161
    v_add_f32 v162, v251, v162
    v_fmac_f32 v249, v195, v187
    v_add_f32 v163, v251, v163
    v_mul_f32 v252, v249, v250
    v_mul_f32 v180, v148, v149
    v_mul_f32 v181, v150, v151
    v_add_u32 v252, v217, v252
    v_mul_f32 v182, v152, v153
    v_mul_f32 v183, v154, v155
    v_mul_f32 v184, v156, v157
    v_mul_f32 v185, v158, v159
    v_mul_f32 v186, v160, v161
    v_mul_f32 v187, v162, v163
    v_mul_f32 v188, v148, v101
    v_mul_f32 v189, v150, v103
    v_mul_f32 v190, v152, v105
    v_mul_f32 v191, v154, v107
    v_mul_f32 v192, v156, v109
    v_mul_f32 v193, v158, v111
    v_mul_f32 v194, v160, v113
    v_mul_f32 v195, v162, v115
    v_fmac_f32 v188, v149, v100
    v_fmac_f32 v189, v151, v102
    v_fmac_f32 v190, v153, v104
    v_fmac_f32 v191, v155, v106
    v_fmac_f32 v192, v157, v108
    v_fmac_f32 v193, v159, v110
    v_fmac_f32 v194, v161, v112
    v_fmac_f32 v195, v163, v114
    v_rcp_f32 v180, v180
    v_rcp_f32 v181, v181
    s_waitcnt lgkmcnt(6)
    v_mfma_f32_32x32x16_bf16 v[148:163], v[36:39], v[116:119], v[84:99]
    v_rcp_f32 v182, v182
    v_rcp_f32 v183, v183
    v_rcp_f32 v184, v184
    v_mfma_f32_32x32x16_bf16 v[148:163], v[40:43], v[120:123], v[148:163]
    v_rcp_f32 v185, v185
    v_rcp_f32 v186, v186
    v_rcp_f32 v187, v187
    s_waitcnt lgkmcnt(4)
    v_mfma_f32_32x32x16_bf16 v[148:163], v[44:47], v[124:127], v[148:163]
    v_exp_f32_e64 v164, v164 clamp
    v_exp_f32_e64 v165, v165 clamp
    v_exp_f32_e64 v166, v166 clamp
    v_mfma_f32_32x32x16_bf16 v[148:163], v[48:51], v[128:131], v[148:163]
    v_exp_f32_e64 v167, v167 clamp
    v_exp_f32_e64 v168, v168 clamp
    v_exp_f32_e64 v169, v169 clamp
    s_waitcnt lgkmcnt(2)
    v_mfma_f32_32x32x16_bf16 v[148:163], v[52:55], v[132:135], v[148:163]
    v_exp_f32_e64 v170, v170 clamp
    v_exp_f32_e64 v171, v171 clamp
    v_exp_f32_e64 v172, v172 clamp
    v_mfma_f32_32x32x16_bf16 v[148:163], v[56:59], v[136:139], v[148:163]
    v_exp_f32_e64 v173, v173 clamp
    v_exp_f32_e64 v174, v174 clamp
    v_exp_f32_e64 v175, v175 clamp
    v_mfma_f32_16x16x32_bf16 v[208:211], v[196:199], v[200:203], v[208:211]
    v_exp_f32_e64 v176, v176 clamp
    v_mfma_f32_16x16x32_bf16 v[212:215], v[196:199], v[204:207], v[212:215]
    v_exp_f32_e64 v177, v177 clamp
    s_waitcnt lgkmcnt(0)
    v_mfma_f32_32x32x16_bf16 v[148:163], v[60:63], v[140:143], v[148:163]
    v_exp_f32_e64 v178, v178 clamp
    v_exp_f32_e64 v179, v179 clamp
    v_mfma_f32_32x32x16_bf16 v[148:163], v[64:67], v[144:147], v[148:163]
    ds_write_b16_d16_hi v244, v252 offset:1536
    ds_read_u16_d16_hi v250, v246 offset:770
    ds_read_b128 v[196:199], v245 offset:2560
    ds_read_b64_tr_b16 v[200:201], v236 offset:34816
    ds_read_b64_tr_b16 v[202:203], v237 offset:35072
    ds_read_b64_tr_b16 v[204:205], v238 offset:34816
    ds_read_b64_tr_b16 v[206:207], v239 offset:35072
    s_waitcnt vmcnt(0)
    s_waitcnt lgkmcnt(5)
    s_barrier
    ds_read_b128 v[116:119], v233 offset:52224
    ds_read_b128 v[120:123], v235 offset:52224
    ds_read_b128 v[124:127], v233 offset:52288
    ds_read_b128 v[128:131], v235 offset:52288
    ds_read_b128 v[132:135], v233 offset:52352
    ds_read_b128 v[136:139], v235 offset:52352
    ds_read_b128 v[140:143], v233 offset:52416
    ds_read_b128 v[144:147], v235 offset:52416
    v_add_f32 v164, v251, v164
    v_fma_f32 v249, v188, v180, v248
    v_add_f32 v165, v251, v165
    v_add_f32 v166, v251, v166
    v_fmac_f32 v249, v189, v181
    v_add_f32 v167, v251, v167
    v_add_f32 v168, v251, v168
    v_fmac_f32 v249, v190, v182
    v_add_f32 v169, v251, v169
    v_add_f32 v170, v251, v170
    v_fmac_f32 v249, v191, v183
    v_add_f32 v171, v251, v171
    v_add_f32 v172, v251, v172
    v_fmac_f32 v249, v192, v184
    v_add_f32 v173, v251, v173
    v_add_f32 v174, v251, v174
    v_fmac_f32 v249, v193, v185
    v_add_f32 v175, v251, v175
    v_add_f32 v176, v251, v176
    v_fmac_f32 v249, v194, v186
    v_add_f32 v177, v251, v177
    v_add_f32 v178, v251, v178
    v_fmac_f32 v249, v195, v187
    v_add_f32 v179, v251, v179
    v_mul_f32 v252, v249, v250
    v_mul_f32 v180, v164, v165
    v_mul_f32 v181, v166, v167
    v_add_u32 v252, v217, v252
    v_mul_f32 v182, v168, v169
    v_mul_f32 v183, v170, v171
    v_mul_f32 v184, v172, v173
    v_mul_f32 v185, v174, v175
    v_mul_f32 v186, v176, v177
    v_mul_f32 v187, v178, v179
    v_mul_f32 v188, v164, v101
    v_mul_f32 v189, v166, v103
    v_mul_f32 v190, v168, v105
    v_mul_f32 v191, v170, v107
    v_mul_f32 v192, v172, v109
    v_mul_f32 v193, v174, v111
    v_mul_f32 v194, v176, v113
    v_mul_f32 v195, v178, v115
    v_fmac_f32 v188, v165, v100
    v_fmac_f32 v189, v167, v102
    v_fmac_f32 v190, v169, v104
    v_fmac_f32 v191, v171, v106
    v_fmac_f32 v192, v173, v108
    v_fmac_f32 v193, v175, v110
    v_fmac_f32 v194, v177, v112
    v_fmac_f32 v195, v179, v114
    v_rcp_f32 v180, v180
    v_rcp_f32 v181, v181
    s_waitcnt lgkmcnt(6)
    v_mfma_f32_32x32x16_bf16 v[164:179], v[36:39], v[116:119], v[84:99]
    v_rcp_f32 v182, v182
    v_rcp_f32 v183, v183
    v_rcp_f32 v184, v184
    v_mfma_f32_32x32x16_bf16 v[164:179], v[40:43], v[120:123], v[164:179]
    v_rcp_f32 v185, v185
    v_rcp_f32 v186, v186
    v_rcp_f32 v187, v187
    s_waitcnt lgkmcnt(4)
    v_mfma_f32_32x32x16_bf16 v[164:179], v[44:47], v[124:127], v[164:179]
    v_exp_f32_e64 v148, v148 clamp
    v_exp_f32_e64 v149, v149 clamp
    v_exp_f32_e64 v150, v150 clamp
    v_mfma_f32_32x32x16_bf16 v[164:179], v[48:51], v[128:131], v[164:179]
    v_exp_f32_e64 v151, v151 clamp
    v_exp_f32_e64 v152, v152 clamp
    v_exp_f32_e64 v153, v153 clamp
    s_waitcnt lgkmcnt(2)
    v_mfma_f32_32x32x16_bf16 v[164:179], v[52:55], v[132:135], v[164:179]
    v_exp_f32_e64 v154, v154 clamp
    v_exp_f32_e64 v155, v155 clamp
    v_exp_f32_e64 v156, v156 clamp
    v_mfma_f32_32x32x16_bf16 v[164:179], v[56:59], v[136:139], v[164:179]
    v_exp_f32_e64 v157, v157 clamp
    v_exp_f32_e64 v158, v158 clamp
    v_exp_f32_e64 v159, v159 clamp
    v_mfma_f32_16x16x32_bf16 v[208:211], v[196:199], v[200:203], v[208:211]
    v_exp_f32_e64 v160, v160 clamp
    v_mfma_f32_16x16x32_bf16 v[212:215], v[196:199], v[204:207], v[212:215]
    v_exp_f32_e64 v161, v161 clamp
    s_waitcnt lgkmcnt(0)
    v_mfma_f32_32x32x16_bf16 v[164:179], v[60:63], v[140:143], v[164:179]
    v_exp_f32_e64 v162, v162 clamp
    v_exp_f32_e64 v163, v163 clamp
    v_mfma_f32_32x32x16_bf16 v[164:179], v[64:67], v[144:147], v[164:179]
    ds_write_b16_d16_hi v244, v252 offset:0
    ds_read_u16_d16_hi v250, v246 offset:1410
    ds_read_b128 v[196:199], v245 offset:1536
    ds_read_b64_tr_b16 v[200:201], v236 offset:52224
    ds_read_b64_tr_b16 v[202:203], v237 offset:52480
    ds_read_b64_tr_b16 v[204:205], v238 offset:52224
    ds_read_b64_tr_b16 v[206:207], v239 offset:52480
    ds_read_b64_tr_b16 v[120:121], v240 offset:17408
    ds_read_b64_tr_b16 v[122:123], v241 offset:17664
    ds_read_b64_tr_b16 v[124:125], v242 offset:17408
    ds_read_b64_tr_b16 v[126:127], v243 offset:17664
    ds_read_b64_tr_b16 v[132:133], v240 offset:34816
    ds_read_b64_tr_b16 v[134:135], v241 offset:35072
    ds_read_b64_tr_b16 v[136:137], v242 offset:34816
    ds_read_b64_tr_b16 v[138:139], v243 offset:35072
    s_waitcnt lgkmcnt(13)
    s_barrier
    v_add_f32 v148, v251, v148
    v_fma_f32 v249, v188, v180, v248
    v_add_f32 v149, v251, v149
    v_add_f32 v150, v251, v150
    v_fmac_f32 v249, v189, v181
    v_add_f32 v151, v251, v151
    v_add_f32 v152, v251, v152
    v_fmac_f32 v249, v190, v182
    v_add_f32 v153, v251, v153
    v_add_f32 v154, v251, v154
    v_fmac_f32 v249, v191, v183
    v_add_f32 v155, v251, v155
    v_add_f32 v156, v251, v156
    v_fmac_f32 v249, v192, v184
    v_add_f32 v157, v251, v157
    v_add_f32 v158, v251, v158
    v_fmac_f32 v249, v193, v185
    v_add_f32 v159, v251, v159
    v_add_f32 v160, v251, v160
    v_fmac_f32 v249, v194, v186
    v_add_f32 v161, v251, v161
    v_add_f32 v162, v251, v162
    v_fmac_f32 v249, v195, v187
    v_add_f32 v163, v251, v163
    v_mul_f32 v252, v249, v250
    v_mul_f32 v180, v148, v149
    v_mul_f32 v181, v150, v151
    v_add_u32 v252, v217, v252
    v_mul_f32 v182, v152, v153
    v_mul_f32 v183, v154, v155
    v_mul_f32 v184, v156, v157
    v_mul_f32 v185, v158, v159
    v_mul_f32 v186, v160, v161
    v_mul_f32 v187, v162, v163
    v_mul_f32 v188, v148, v101
    v_mul_f32 v189, v150, v103
    v_mul_f32 v190, v152, v105
    v_mul_f32 v191, v154, v107
    v_mul_f32 v192, v156, v109
    v_mul_f32 v193, v158, v111
    v_mul_f32 v194, v160, v113
    v_mul_f32 v195, v162, v115
    v_fmac_f32 v188, v149, v100
    v_fmac_f32 v189, v151, v102
    v_fmac_f32 v190, v153, v104
    v_fmac_f32 v191, v155, v106
    v_fmac_f32 v192, v157, v108
    v_fmac_f32 v193, v159, v110
    v_fmac_f32 v194, v161, v112
    v_fmac_f32 v195, v163, v114
    v_rcp_f32 v180, v180
    v_rcp_f32 v181, v181
    v_rcp_f32 v182, v182
    v_rcp_f32 v183, v183
    v_rcp_f32 v184, v184
    v_rcp_f32 v185, v185
    v_rcp_f32 v186, v186
    v_rcp_f32 v187, v187
    v_exp_f32_e64 v164, v164 clamp
    v_exp_f32_e64 v165, v165 clamp
    v_exp_f32_e64 v166, v166 clamp
    v_exp_f32_e64 v167, v167 clamp
    v_exp_f32_e64 v168, v168 clamp
    v_exp_f32_e64 v169, v169 clamp
    v_exp_f32_e64 v170, v170 clamp
    v_exp_f32_e64 v171, v171 clamp
    v_exp_f32_e64 v172, v172 clamp
    v_exp_f32_e64 v173, v173 clamp
    v_exp_f32_e64 v174, v174 clamp
    v_exp_f32_e64 v175, v175 clamp
    v_exp_f32_e64 v176, v176 clamp
    s_waitcnt lgkmcnt(8)
    v_mfma_f32_16x16x32_bf16 v[208:211], v[196:199], v[200:203], v[208:211]
    v_exp_f32_e64 v177, v177 clamp
    v_mfma_f32_16x16x32_bf16 v[212:215], v[196:199], v[204:207], v[212:215]
    v_exp_f32_e64 v178, v178 clamp
    v_exp_f32_e64 v179, v179 clamp
    ds_write_b16_d16_hi v247, v252 offset:2560
    ds_read_u16_d16_hi v250, v246 offset:1538
    ds_read_b128 v[196:199], v245 offset:0
    ds_read_b64_tr_b16 v[200:201], v240 offset:0
    ds_read_b64_tr_b16 v[202:203], v241 offset:256
    ds_read_b64_tr_b16 v[204:205], v242 offset:0
    ds_read_b64_tr_b16 v[206:207], v243 offset:256
    s_waitcnt lgkmcnt(11)
    ds_read_b64_tr_b16 v[140:141], v240 offset:52224
    ds_read_b64_tr_b16 v[142:143], v241 offset:52480
    ds_read_b64_tr_b16 v[144:145], v242 offset:52224
    ds_read_b64_tr_b16 v[146:147], v243 offset:52480
    s_waitcnt lgkmcnt(9)
    s_barrier
    v_add_f32 v164, v251, v164
    v_fma_f32 v249, v188, v180, v248
    v_add_f32 v165, v251, v165
    v_add_f32 v166, v251, v166
    v_fmac_f32 v249, v189, v181
    v_add_f32 v167, v251, v167
    v_add_f32 v168, v251, v168
    v_fmac_f32 v249, v190, v182
    v_add_f32 v169, v251, v169
    v_add_f32 v170, v251, v170
    v_fmac_f32 v249, v191, v183
    v_add_f32 v171, v251, v171
    v_add_f32 v172, v251, v172
    v_fmac_f32 v249, v192, v184
    v_add_f32 v173, v251, v173
    v_add_f32 v174, v251, v174
    v_fmac_f32 v249, v193, v185
    v_add_f32 v175, v251, v175
    v_add_f32 v176, v251, v176
    v_fmac_f32 v249, v194, v186
    v_add_f32 v177, v251, v177
    v_add_f32 v178, v251, v178
    v_fmac_f32 v249, v195, v187
    v_add_f32 v179, v251, v179
    v_mul_f32 v252, v249, v250
    v_mul_f32 v180, v164, v165
    v_mul_f32 v181, v166, v167
    v_add_u32 v252, v217, v252
    v_mul_f32 v182, v168, v169
    v_mul_f32 v183, v170, v171
    v_mul_f32 v184, v172, v173
    v_mul_f32 v185, v174, v175
    v_mul_f32 v186, v176, v177
    v_mul_f32 v187, v178, v179
    v_mul_f32 v188, v164, v101
    v_mul_f32 v189, v166, v103
    v_mul_f32 v190, v168, v105
    v_mul_f32 v191, v170, v107
    v_mul_f32 v192, v172, v109
    v_mul_f32 v193, v174, v111
    v_mul_f32 v194, v176, v113
    v_mul_f32 v195, v178, v115
    v_fmac_f32 v188, v165, v100
    v_fmac_f32 v189, v167, v102
    v_fmac_f32 v190, v169, v104
    v_fmac_f32 v191, v171, v106
    v_fmac_f32 v192, v173, v108
    v_fmac_f32 v193, v175, v110
    v_fmac_f32 v194, v177, v112
    v_fmac_f32 v195, v179, v114
    ds_read_u16_d16_hi v250, v246 offset:1666
    ds_read_b128 v[116:119], v245 offset:2048
    ds_write_b16_d16_hi v247, v252 offset:1024
    v_rcp_f32 v180, v180
    v_rcp_f32 v181, v181
    v_rcp_f32 v182, v182
    v_rcp_f32 v183, v183
    v_rcp_f32 v184, v184
    s_waitcnt lgkmcnt(7)
    v_mfma_f32_16x16x32_bf16 v[208:211], v[196:199], v[200:203], v[208:211]
    v_rcp_f32 v185, v185
    v_mfma_f32_16x16x32_bf16 v[212:215], v[196:199], v[204:207], v[212:215]
    v_rcp_f32 v186, v186
    v_rcp_f32 v187, v187
    v_fma_f32 v249, v188, v180, v248
    v_mul_f32 v248, v189, v181
    v_fmac_f32 v249, v190, v182
    v_fmac_f32 v248, v191, v183
    v_fmac_f32 v249, v192, v184
    v_fmac_f32 v248, v193, v185
    v_fmac_f32 v249, v194, v186
    v_fmac_f32 v248, v195, v187
    v_add_f32 v249, v249, v248
    s_waitcnt lgkmcnt(2)
    v_mul_f32 v249, v249, v250
    v_add_u32 v249, s78, v249
    ds_write_b16_d16_hi v247, v249 offset:3584
    s_waitcnt lgkmcnt(2)
    v_mfma_f32_16x16x32_bf16 v[208:211], v[116:119], v[120:123], v[208:211]
    v_mfma_f32_16x16x32_bf16 v[212:215], v[116:119], v[124:127], v[212:215]
    v_mbcnt_lo_u32_b32 v0, -1, 0
    v_mbcnt_hi_u32_b32 v0, -1, v0
    s_lshl_b32 s31, s29, 9
    v_and_b32 v1, 32, v0
    s_lshl_b32 s32, s30, 6
    v_mul_u32_u24 v1, 6, v1
    s_add_u32 s31, s31, s32
    v_lshl_add_u32 v0, v0, 1, v1
    v_add_u32 v0, s31, v0
    s_waitcnt lgkmcnt(0)
    s_barrier
    ds_read_b128 v[128:131], v245 offset:512
    ds_read_b128 v[196:199], v245 offset:3072
    s_waitcnt lgkmcnt(1)
    v_mfma_f32_16x16x32_bf16 v[208:211], v[128:131], v[132:135], v[208:211]
    v_mfma_f32_16x16x32_bf16 v[212:215], v[128:131], v[136:139], v[212:215]
    s_waitcnt lgkmcnt(0)
    v_mfma_f32_16x16x32_bf16 v[208:211], v[196:199], v[140:143], v[208:211]
    v_mfma_f32_16x16x32_bf16 v[212:215], v[196:199], v[144:147], v[212:215]
    s_nop 6
    v_add_f32 v208, v208, v209
    v_add_f32 v210, v210, v211
    v_add_f32 v212, v212, v213
    v_add_f32 v214, v214, v215
    v_add_f32 v208, v208, v210
    v_add_f32 v212, v212, v214
    s_nop 1
    v_permlane16_swap_b32 v208, v212
    s_nop 1
    v_add_f32 v208, v208, v212
    v_mul_f32 v208, v251, v208
    v_cvt_pk_bf16_f32 v208, v208, v208
    global_store_short v0, v208, s[18:19]
    s_endpgm
L_g1:
    s_setprio 2
    s_add_u32 m0, s74, 50176
    s_add_u32 s37, s75, 8192
    buffer_load_dwordx4 v89, s[24:27], s37 offen offset:0 lds
    buffer_load_dwordx4 v89, s[24:27], s37 offen offset:1024 lds
    buffer_load_dwordx4 v90, s[24:27], s37 offen offset:2048 lds
    buffer_load_dwordx4 v90, s[24:27], s37 offen offset:3072 lds
    s_waitcnt lgkmcnt(0)
    v_mov_b32 v154, s40
    v_mov_b32 v155, s41
    v_mov_b32 v156, s44
    v_mov_b32 v157, s45
    v_mov_b32 v158, s48
    v_mov_b32 v159, s49
    v_mov_b32 v160, s52
    v_mov_b32 v161, s53
    v_mov_b32 v162, s56
    v_mov_b32 v163, s57
    s_lshl_b32 s76, s72, 16
    s_cmp_eq_u32 s30, 0
    s_cselect_b32 s76, s76, 0
    v_mov_b32 v248, s76
    s_mov_b32 exec_lo, 0xffff0000
    v_mov_b32 v162, s58
    v_mov_b32 v163, s59
    s_mov_b32 exec_lo, 0
    v_mov_b32 v154, s42
    v_mov_b32 v155, s43
    v_mov_b32 v156, s46
    v_mov_b32 v157, s47
    v_mov_b32 v158, s50
    v_mov_b32 v159, s51
    v_mov_b32 v160, s54
    v_mov_b32 v161, s55
    v_mov_b32 v248, 0
    v_mov_b32 v162, s60
    v_mov_b32 v163, s61
    s_mov_b32 exec_hi, 0xffff0000
    v_mov_b32 v162, s62
    v_mov_b32 v163, s63
    s_mov_b64 exec, -1
    v_lshlrev_b32 v100, 16, v154
    v_and_b32 v101, 0xffff0000, v154
    v_lshlrev_b32 v102, 16, v155
    v_and_b32 v103, 0xffff0000, v155
    v_lshlrev_b32 v104, 16, v156
    v_and_b32 v105, 0xffff0000, v156
    v_lshlrev_b32 v106, 16, v157
    v_and_b32 v107, 0xffff0000, v157
    v_lshlrev_b32 v108, 16, v158
    v_and_b32 v109, 0xffff0000, v158
    v_lshlrev_b32 v110, 16, v159
    v_and_b32 v111, 0xffff0000, v159
    v_lshlrev_b32 v112, 16, v160
    v_and_b32 v113, 0xffff0000, v160
    v_lshlrev_b32 v114, 16, v161
    v_and_b32 v115, 0xffff0000, v161
    v_lshlrev_b32 v96, 16, v162
    v_and_b32 v97, 0xffff0000, v162
    v_lshlrev_b32 v98, 16, v163
    v_and_b32 v99, 0xffff0000, v163
    v_fmaak_f32 v96, v96, v251, 0xc2200000
    v_fmaak_f32 v97, v97, v251, 0xc2200000
    v_fmaak_f32 v98, v98, v251, 0xc2200000
    v_fmaak_f32 v99, v99, v251, 0xc2200000
    v_mul_f32 v248, 0x53800000, v248
    s_waitcnt vmcnt(4)
    s_barrier
    s_waitcnt vmcnt(9)
    v_lshl_or_b32 v72, v68, 16, v76
    v_and_or_b32 v73, v68, s73, v77
    v_lshl_or_b32 v74, v69, 16, v78
    v_and_or_b32 v75, v69, s73, v79
    v_cmp_neq_f16_sdwa s[64:65], v72, v80 src0_sel:WORD_1 src1_sel:DWORD
    v_cmp_neq_f16_sdwa s[66:67], v73, v80 src0_sel:WORD_1 src1_sel:DWORD
    v_cmp_neq_f16_sdwa s[68:69], v74, v80 src0_sel:WORD_1 src1_sel:DWORD
    v_cmp_neq_f16_sdwa s[70:71], v75, v80 src0_sel:WORD_1 src1_sel:DWORD
    v_mbcnt_lo_u32_b32 v76, s64, 0
    v_mbcnt_lo_u32_b32 v77, s66, 0
    v_mbcnt_lo_u32_b32 v78, s68, 0
    v_mbcnt_lo_u32_b32 v79, s70, 0
    v_mbcnt_hi_u32_b32 v76, s65, v76
    s_bcnt1_i32_b64 s31, s[64:65]
    s_lshl_b32 s31, s31, 2
    s_sub_u32 s33, s33, s31
    v_lshl_add_u32 v76, v76, 2, s33
    v_mbcnt_hi_u32_b32 v77, s67, v77
    s_bcnt1_i32_b64 s31, s[66:67]
    s_lshl_b32 s31, s31, 2
    s_sub_u32 s33, s33, s31
    v_lshl_add_u32 v77, v77, 2, s33
    v_mbcnt_hi_u32_b32 v78, s69, v78
    s_bcnt1_i32_b64 s31, s[68:69]
    s_lshl_b32 s31, s31, 2
    s_sub_u32 s33, s33, s31
    v_lshl_add_u32 v78, v78, 2, s33
    v_mbcnt_hi_u32_b32 v79, s71, v79
    s_bcnt1_i32_b64 s31, s[70:71]
    s_lshl_b32 s31, s31, 2
    s_sub_u32 s33, s33, s31
    v_lshl_add_u32 v79, v79, 2, s33
    v_cndmask_b32 v76, v82, v76, s[64:65]
    v_cndmask_b32 v77, v82, v77, s[66:67]
    v_cndmask_b32 v78, v82, v78, s[68:69]
    v_cndmask_b32 v79, v82, v79, s[70:71]
    s_add_u32 m0, s35, 82944
    s_add_u32 s37, s36, 16384
    buffer_load_dwordx4 v89, s[24:27], s37 offen offset:0 lds
    buffer_load_dwordx4 v89, s[24:27], s37 offen offset:1024 lds
    buffer_load_dwordx4 v90, s[24:27], s37 offen offset:2048 lds
    buffer_load_dwordx4 v90, s[24:27], s37 offen offset:3072 lds
    ds_read2_b32 v[188:189], v252 offset0:0 offset1:8
    ds_read2_b32 v[190:191], v252 offset0:16 offset1:24
    ds_read2_b32 v[192:193], v252 offset0:32 offset1:40
    ds_read2_b32 v[194:195], v252 offset0:48 offset1:56
    ds_read_b64_tr_b16 v[116:117], v84 offset:0
    ds_read_b64_tr_b16 v[118:119], v84 offset:1024
    ds_read_b64_tr_b16 v[124:125], v84 offset:16384
    ds_read_b64_tr_b16 v[126:127], v84 offset:17408
    ds_read_b64_tr_b16 v[132:133], v84 offset:24576
    ds_read_b64_tr_b16 v[134:135], v84 offset:25600
    ds_read_b64_tr_b16 v[120:121], v84 offset:4096
    ds_read_b64_tr_b16 v[122:123], v84 offset:5120
    ds_read_b64_tr_b16 v[128:129], v84 offset:20480
    ds_read_b64_tr_b16 v[130:131], v84 offset:21504
    ds_read_b64_tr_b16 v[136:137], v84 offset:28672
    s_waitcnt lgkmcnt(11)
    ds_read_b64_tr_b16 v[138:139], v84 offset:29696
    ds_read_b128 v[196:199], v88 offset:0
    ds_read_b64_tr_b16 v[140:141], v86 offset:8192
    ds_read_b64_tr_b16 v[142:143], v86 offset:9216
    s_waitcnt lgkmcnt(11)
    ds_read_b64_tr_b16 v[144:145], v86 offset:16384
    ds_read_b64_tr_b16 v[146:147], v86 offset:17408
    ds_write_b32 v76, v72
    ds_write_b32 v77, v73
    s_waitcnt lgkmcnt(11)
    ds_write_b32 v78, v74
    ds_write_b32 v79, v75
    s_waitcnt vmcnt(4)
    s_waitcnt lgkmcnt(0)
    s_barrier
    v_mfma_f32_32x32x16_bf16 v[164:179], v[200:203], v[116:119], 0
    v_and_b32 v180, v188, v204
    v_and_b32 v181, v188, v205
    v_and_b32 v182, v188, v206
    v_and_b32 v183, v188, v207
    s_nop 0
    v_mfma_f32_32x32x16_bf16 v[164:179], v[200:203], v[124:127], v[164:179]
    v_mfma_f32_32x32x16_bf16 v[164:179], v[180:183], v[132:135], v[164:179]
    v_mfma_f32_32x32x16_bf16 v[216:231], v[200:203], v[120:123], 0
    v_mfma_f32_16x16x32_bf16 v[208:211], v[140:143], v[196:199], 0
    v_mfma_f32_16x16x32_bf16 v[212:215], v[144:147], v[196:199], 0
    v_and_b32 v184, v189, v204
    v_and_b32 v185, v189, v205
    v_and_b32 v186, v189, v206
    v_and_b32 v187, v189, v207
    s_nop 4
    v_mul_f32 v164, v251, v164
    v_mul_f32 v165, v251, v165
    v_mul_f32 v166, v251, v166
    v_mul_f32 v167, v251, v167
    v_mul_f32 v168, v251, v168
    v_mul_f32 v169, v251, v169
    v_mfma_f32_32x32x16_bf16 v[216:231], v[200:203], v[128:131], v[216:231]
    v_mul_f32 v170, v251, v170
    v_mul_f32 v171, v251, v171
    v_cvt_pk_bf16_f32 v4, v164, v165
    v_cvt_pk_bf16_f32 v5, v166, v167
    v_cvt_pk_bf16_f32 v6, v168, v169
    v_cvt_pk_bf16_f32 v7, v170, v171
    v_mul_f32 v172, v251, v172
    v_mul_f32 v173, v251, v173
    v_mul_f32 v174, v251, v174
    v_mfma_f32_32x32x16_bf16 v[216:231], v[184:187], v[136:139], v[216:231]
    v_mul_f32 v175, v251, v175
    v_mul_f32 v176, v251, v176
    v_mul_f32 v177, v251, v177
    v_mul_f32 v178, v251, v178
    v_mul_f32 v179, v251, v179
    v_cvt_pk_bf16_f32 v36, v172, v173
    v_cvt_pk_bf16_f32 v37, v174, v175
    v_cvt_pk_bf16_f32 v38, v176, v177
    v_cvt_pk_bf16_f32 v39, v178, v179
    ds_read_u16 v148, v253 offset:384
    ds_read_u16 v149, v253 offset:2176
    ds_read_u16 v150, v253 offset:1280
    ds_read_u16 v151, v253 offset:3072
    ds_read_u16 v152, v253 offset:512
    ds_read_b64_tr_b16 v[116:117], v84 offset:32768
    ds_read_b64_tr_b16 v[118:119], v84 offset:33792
    ds_read_b64_tr_b16 v[124:125], v84 offset:49152
    ds_read_b64_tr_b16 v[126:127], v84 offset:50176
    s_add_u32 m0, s35, 115712
    s_add_u32 s37, s36, 24576
    buffer_load_dwordx4 v89, s[24:27], s37 offen offset:0 lds
    ds_read_b64_tr_b16 v[132:133], v84 offset:57344
    ds_read_b64_tr_b16 v[134:135], v84 offset:58368
    ds_read_b64_tr_b16 v[120:121], v84 offset:36864
    ds_read_b64_tr_b16 v[122:123], v84 offset:37888
    buffer_load_dwordx4 v89, s[24:27], s37 offen offset:1024 lds
    ds_read_b64_tr_b16 v[128:129], v84 offset:53248
    ds_read_b64_tr_b16 v[130:131], v84 offset:54272
    s_waitcnt lgkmcnt(11)
    ds_read_b64_tr_b16 v[136:137], v84 offset:61440
    ds_read_b64_tr_b16 v[138:139], v84 offset:62464
    buffer_load_dwordx4 v90, s[24:27], s37 offen offset:2048 lds
    ds_read_b128 v[196:199], v88 offset:64
    ds_read_b64_tr_b16 v[140:141], v86 offset:40960
    s_waitcnt lgkmcnt(11)
    ds_read_b64_tr_b16 v[142:143], v86 offset:41984
    ds_read_b64_tr_b16 v[144:145], v86 offset:49152
    ds_read_b64_tr_b16 v[146:147], v86 offset:50176
    buffer_load_dwordx4 v90, s[24:27], s37 offen offset:3072 lds
    v_lshl_add_u32 v148, v148, 8, v254
    v_lshl_add_u32 v149, v149, 8, v254
    v_lshl_add_u32 v150, v150, 8, v254
    v_lshl_add_u32 v151, v151, 8, v254
    v_lshl_add_u32 v152, v152, 8, v254
    s_waitcnt vmcnt(4)
    s_waitcnt lgkmcnt(0)
    s_barrier
    v_mfma_f32_32x32x16_bf16 v[164:179], v[200:203], v[116:119], 0
    v_and_b32 v180, v190, v204
    v_and_b32 v181, v190, v205
    v_and_b32 v182, v190, v206
    v_and_b32 v183, v190, v207
    v_mul_f32 v216, v251, v216
    v_mul_f32 v217, v251, v217
    v_mul_f32 v218, v251, v218
    v_mul_f32 v219, v251, v219
    v_mul_f32 v220, v251, v220
    v_mfma_f32_32x32x16_bf16 v[164:179], v[200:203], v[124:127], v[164:179]
    v_mul_f32 v221, v251, v221
    v_mul_f32 v222, v251, v222
    v_mul_f32 v223, v251, v223
    v_cvt_pk_bf16_f32 v8, v216, v217
    v_cvt_pk_bf16_f32 v9, v218, v219
    v_cvt_pk_bf16_f32 v10, v220, v221
    v_cvt_pk_bf16_f32 v11, v222, v223
    v_mul_f32 v224, v251, v224
    v_mul_f32 v225, v251, v225
    v_mul_f32 v226, v251, v226
    v_mfma_f32_32x32x16_bf16 v[164:179], v[180:183], v[132:135], v[164:179]
    v_mul_f32 v227, v251, v227
    v_mul_f32 v228, v251, v228
    v_mul_f32 v229, v251, v229
    v_mul_f32 v230, v251, v230
    v_mul_f32 v231, v251, v231
    v_cvt_pk_bf16_f32 v40, v224, v225
    v_cvt_pk_bf16_f32 v41, v226, v227
    v_cvt_pk_bf16_f32 v42, v228, v229
    v_cvt_pk_bf16_f32 v43, v230, v231
    v_mfma_f32_32x32x16_bf16 v[216:231], v[200:203], v[120:123], 0
    v_mfma_f32_16x16x32_bf16 v[208:211], v[140:143], v[196:199], v[208:211]
    v_mfma_f32_16x16x32_bf16 v[212:215], v[144:147], v[196:199], v[212:215]
    v_and_b32 v184, v191, v204
    v_and_b32 v185, v191, v205
    v_and_b32 v186, v191, v206
    v_and_b32 v187, v191, v207
    v_mul_f32 v164, v251, v164
    v_mul_f32 v165, v251, v165
    v_mul_f32 v166, v251, v166
    v_mul_f32 v167, v251, v167
    v_mul_f32 v168, v251, v168
    v_mul_f32 v169, v251, v169
    v_mfma_f32_32x32x16_bf16 v[216:231], v[200:203], v[128:131], v[216:231]
    v_mul_f32 v170, v251, v170
    v_mul_f32 v171, v251, v171
    v_cvt_pk_bf16_f32 v12, v164, v165
    v_cvt_pk_bf16_f32 v13, v166, v167
    v_cvt_pk_bf16_f32 v14, v168, v169
    v_cvt_pk_bf16_f32 v15, v170, v171
    v_mul_f32 v172, v251, v172
    v_mul_f32 v173, v251, v173
    v_mul_f32 v174, v251, v174
    v_mfma_f32_32x32x16_bf16 v[216:231], v[184:187], v[136:139], v[216:231]
    v_mul_f32 v175, v251, v175
    v_mul_f32 v176, v251, v176
    v_mul_f32 v177, v251, v177
    v_mul_f32 v178, v251, v178
    v_mul_f32 v179, v251, v179
    v_cvt_pk_bf16_f32 v44, v172, v173
    v_cvt_pk_bf16_f32 v45, v174, v175
    v_cvt_pk_bf16_f32 v46, v176, v177
    v_cvt_pk_bf16_f32 v47, v178, v179
    ds_read_u16 v153, v253 offset:2304
    ds_read_u16 v154, v253 offset:640
    ds_read_u16 v70, v83
    ds_read_b128 v[196:199], v88 offset:128
    ds_read_b64_tr_b16 v[140:141], v87 offset:8192
    ds_read_b64_tr_b16 v[142:143], v87 offset:9216
    ds_read_b64_tr_b16 v[144:145], v87 offset:16384
    s_add_u32 m0, s34, 0
    s_nop 0
    buffer_load_dwordx4 v148, s[20:23], 0 offen nt lds
    s_add_u32 m0, s34, 8704
    s_nop 0
    buffer_load_dwordx4 v149, s[20:23], 0 offen nt lds
    ds_read_b64_tr_b16 v[146:147], v87 offset:17408
    ds_read_b64_tr_b16 v[116:117], v85 offset:0
    ds_read_b64_tr_b16 v[118:119], v85 offset:1024
    ds_read_b64_tr_b16 v[124:125], v85 offset:16384
    s_add_u32 m0, s34, 17408
    s_nop 0
    buffer_load_dwordx4 v150, s[20:23], 0 offen nt lds
    ds_read_b64_tr_b16 v[126:127], v85 offset:17408
    ds_read_b64_tr_b16 v[132:133], v85 offset:24576
    ds_read_b64_tr_b16 v[134:135], v85 offset:25600
    ds_read_b64_tr_b16 v[120:121], v85 offset:4096
    s_add_u32 m0, s34, 26112
    s_nop 0
    buffer_load_dwordx4 v151, s[20:23], 0 offen nt lds
    s_waitcnt lgkmcnt(11)
    ds_read_b64_tr_b16 v[122:123], v85 offset:5120
    ds_read_b64_tr_b16 v[128:129], v85 offset:20480
    ds_read_b64_tr_b16 v[130:131], v85 offset:21504
    ds_read_b64_tr_b16 v[136:137], v85 offset:28672
    s_waitcnt lgkmcnt(11)
    ds_read_b64_tr_b16 v[138:139], v85 offset:29696
    s_add_u32 m0, s34, 34816
    s_nop 0
    buffer_load_dwordx4 v152, s[20:23], 0 offen nt lds
    v_lshl_add_u32 v153, v153, 8, v254
    v_lshl_add_u32 v154, v154, 8, v254
    v_cmp_gt_u32 vcc, s78, v70
    s_nop 0
    s_mov_b32 s79, vcc_lo
    v_mfma_f32_16x16x32_bf16 v[208:211], v[140:143], v[196:199], v[208:211]
    v_mfma_f32_16x16x32_bf16 v[212:215], v[144:147], v[196:199], v[212:215]
    s_waitcnt vmcnt(5)
    s_barrier
    ds_read_b128 v[196:199], v88 offset:192
    ds_read_b64_tr_b16 v[140:141], v87 offset:40960
    ds_read_b64_tr_b16 v[142:143], v87 offset:41984
    s_waitcnt lgkmcnt(11)
    ds_read_b64_tr_b16 v[144:145], v87 offset:49152
    ds_read_b64_tr_b16 v[146:147], v87 offset:50176
    v_mfma_f32_32x32x16_bf16 v[164:179], v[200:203], v[116:119], 0
    v_and_b32 v180, v192, v204
    v_and_b32 v181, v192, v205
    v_and_b32 v182, v192, v206
    v_and_b32 v183, v192, v207
    v_mul_f32 v216, v251, v216
    v_mul_f32 v217, v251, v217
    v_mul_f32 v218, v251, v218
    v_mul_f32 v219, v251, v219
    v_mul_f32 v220, v251, v220
    v_mfma_f32_32x32x16_bf16 v[164:179], v[200:203], v[124:127], v[164:179]
    v_mul_f32 v221, v251, v221
    v_mul_f32 v222, v251, v222
    v_mul_f32 v223, v251, v223
    v_cvt_pk_bf16_f32 v16, v216, v217
    v_cvt_pk_bf16_f32 v17, v218, v219
    v_cvt_pk_bf16_f32 v18, v220, v221
    v_cvt_pk_bf16_f32 v19, v222, v223
    v_mul_f32 v224, v251, v224
    v_mul_f32 v225, v251, v225
    v_mul_f32 v226, v251, v226
    s_waitcnt lgkmcnt(11)
    v_mfma_f32_32x32x16_bf16 v[164:179], v[180:183], v[132:135], v[164:179]
    v_mul_f32 v227, v251, v227
    v_mul_f32 v228, v251, v228
    v_mul_f32 v229, v251, v229
    v_mul_f32 v230, v251, v230
    v_mul_f32 v231, v251, v231
    v_cvt_pk_bf16_f32 v48, v224, v225
    v_cvt_pk_bf16_f32 v49, v226, v227
    v_cvt_pk_bf16_f32 v50, v228, v229
    v_cvt_pk_bf16_f32 v51, v230, v231
    s_waitcnt lgkmcnt(9)
    v_mfma_f32_32x32x16_bf16 v[216:231], v[200:203], v[120:123], 0
    v_and_b32 v184, v193, v204
    v_and_b32 v185, v193, v205
    v_and_b32 v186, v193, v206
    v_and_b32 v187, v193, v207
    s_waitcnt lgkmcnt(0)
    v_mfma_f32_16x16x32_bf16 v[208:211], v[140:143], v[196:199], v[208:211]
    v_mfma_f32_16x16x32_bf16 v[212:215], v[144:147], v[196:199], v[212:215]
    v_mul_f32 v164, v251, v164
    v_mul_f32 v165, v251, v165
    v_mul_f32 v166, v251, v166
    v_mul_f32 v167, v251, v167
    v_mul_f32 v168, v251, v168
    v_mul_f32 v169, v251, v169
    v_mfma_f32_32x32x16_bf16 v[216:231], v[200:203], v[128:131], v[216:231]
    v_mul_f32 v170, v251, v170
    v_mul_f32 v171, v251, v171
    v_cvt_pk_bf16_f32 v20, v164, v165
    v_cvt_pk_bf16_f32 v21, v166, v167
    v_cvt_pk_bf16_f32 v22, v168, v169
    v_cvt_pk_bf16_f32 v23, v170, v171
    v_mul_f32 v172, v251, v172
    v_mul_f32 v173, v251, v173
    v_mul_f32 v174, v251, v174
    v_mfma_f32_32x32x16_bf16 v[216:231], v[184:187], v[136:139], v[216:231]
    v_mul_f32 v175, v251, v175
    v_mul_f32 v176, v251, v176
    v_mul_f32 v177, v251, v177
    v_mul_f32 v178, v251, v178
    v_mul_f32 v179, v251, v179
    v_cvt_pk_bf16_f32 v52, v172, v173
    v_cvt_pk_bf16_f32 v53, v174, v175
    v_cvt_pk_bf16_f32 v54, v176, v177
    v_cvt_pk_bf16_f32 v55, v178, v179
    v_sub_f32 v208, v208, v212
    v_sub_f32 v209, v209, v213
    v_sub_f32 v210, v210, v214
    v_sub_f32 v211, v211, v215
    v_fma_f32 v208, v208, v251, v96
    v_fma_f32 v209, v209, v251, v97
    v_fma_f32 v210, v210, v251, v98
    v_fma_f32 v211, v211, v251, v99
    ds_read_b64_tr_b16 v[116:117], v85 offset:32768
    ds_read_b64_tr_b16 v[118:119], v85 offset:33792
    ds_read_b64_tr_b16 v[124:125], v85 offset:49152
    ds_read_b64_tr_b16 v[126:127], v85 offset:50176
    s_add_u32 m0, s34, 43520
    s_nop 0
    buffer_load_dwordx4 v153, s[20:23], 0 offen nt lds
    ds_read_b64_tr_b16 v[132:133], v85 offset:57344
    ds_read_b64_tr_b16 v[134:135], v85 offset:58368
    ds_read_b64_tr_b16 v[120:121], v85 offset:36864
    ds_read_b64_tr_b16 v[122:123], v85 offset:37888
    s_add_u32 m0, s34, 52224
    s_nop 0
    buffer_load_dwordx4 v154, s[20:23], 0 offen nt lds
    ds_read_b64_tr_b16 v[128:129], v85 offset:53248
    ds_read_b64_tr_b16 v[130:131], v85 offset:54272
    ds_read_b64_tr_b16 v[136:137], v85 offset:61440
    ds_read_b64_tr_b16 v[138:139], v85 offset:62464
    s_mov_b32 exec_lo, 0x000f000f
    s_mov_b32 exec_hi, 0x000f000f
    ds_write_b128 v93, v[208:211]
    s_mov_b64 exec, -1
    s_waitcnt vmcnt(3)
    s_waitcnt lgkmcnt(0)
    s_barrier
    s_setprio 0
    v_mfma_f32_32x32x16_bf16 v[164:179], v[200:203], v[116:119], 0
    v_and_b32 v180, v194, v204
    v_and_b32 v181, v194, v205
    v_and_b32 v182, v194, v206
    v_and_b32 v183, v194, v207
    v_mul_f32 v216, v251, v216
    v_mul_f32 v217, v251, v217
    v_mul_f32 v218, v251, v218
    v_mul_f32 v219, v251, v219
    v_mul_f32 v220, v251, v220
    v_mfma_f32_32x32x16_bf16 v[164:179], v[200:203], v[124:127], v[164:179]
    v_mul_f32 v221, v251, v221
    v_mul_f32 v222, v251, v222
    v_mul_f32 v223, v251, v223
    v_cvt_pk_bf16_f32 v24, v216, v217
    v_cvt_pk_bf16_f32 v25, v218, v219
    v_cvt_pk_bf16_f32 v26, v220, v221
    v_cvt_pk_bf16_f32 v27, v222, v223
    v_mul_f32 v224, v251, v224
    v_mul_f32 v225, v251, v225
    v_mul_f32 v226, v251, v226
    v_mfma_f32_32x32x16_bf16 v[164:179], v[180:183], v[132:135], v[164:179]
    v_mul_f32 v227, v251, v227
    v_mul_f32 v228, v251, v228
    v_mul_f32 v229, v251, v229
    v_mul_f32 v230, v251, v230
    v_mul_f32 v231, v251, v231
    v_cvt_pk_bf16_f32 v56, v224, v225
    v_cvt_pk_bf16_f32 v57, v226, v227
    v_cvt_pk_bf16_f32 v58, v228, v229
    v_cvt_pk_bf16_f32 v59, v230, v231
    v_mfma_f32_32x32x16_bf16 v[216:231], v[200:203], v[120:123], 0
    v_and_b32 v184, v195, v204
    v_and_b32 v185, v195, v205
    v_and_b32 v186, v195, v206
    v_and_b32 v187, v195, v207
    ds_read_b128 v[68:71], v249 offset:0
    ds_read_b128 v[72:75], v249 offset:32
    ds_read_b128 v[76:79], v249 offset:64
    ds_read_b128 v[80:83], v249 offset:96
    ds_read_b128 v[116:119], v232 offset:0
    ds_read_b128 v[124:127], v232 offset:64
    ds_read_b128 v[132:135], v232 offset:128
    ds_read_b128 v[140:143], v232 offset:192
    ds_read_b128 v[144:147], v234 offset:192
    v_mul_f32 v164, v251, v164
    v_mul_f32 v165, v251, v165
    v_mul_f32 v166, v251, v166
    v_mul_f32 v167, v251, v167
    v_mul_f32 v168, v251, v168
    v_mul_f32 v169, v251, v169
    v_mfma_f32_32x32x16_bf16 v[216:231], v[200:203], v[128:131], v[216:231]
    v_mul_f32 v170, v251, v170
    v_mul_f32 v171, v251, v171
    v_cvt_pk_bf16_f32 v28, v164, v165
    v_cvt_pk_bf16_f32 v29, v166, v167
    v_cvt_pk_bf16_f32 v30, v168, v169
    v_cvt_pk_bf16_f32 v31, v170, v171
    v_mul_f32 v172, v251, v172
    v_mul_f32 v173, v251, v173
    v_mul_f32 v174, v251, v174
    v_mfma_f32_32x32x16_bf16 v[216:231], v[184:187], v[136:139], v[216:231]
    v_mul_f32 v175, v251, v175
    v_mul_f32 v176, v251, v176
    v_mul_f32 v177, v251, v177
    v_mul_f32 v178, v251, v178
    v_mul_f32 v179, v251, v179
    v_cvt_pk_bf16_f32 v60, v172, v173
    v_cvt_pk_bf16_f32 v61, v174, v175
    v_cvt_pk_bf16_f32 v62, v176, v177
    v_cvt_pk_bf16_f32 v63, v178, v179
    s_cmp_lg_u32 s79, 0
    s_cbranch_scc1 L_slow
    ds_read_b128 v[120:123], v234 offset:0
    ds_read_b128 v[128:131], v234 offset:64
    ds_read_b128 v[136:139], v234 offset:128
    s_waitcnt lgkmcnt(7)
    v_mfma_f32_32x32x16_bf16 v[148:163], v[4:7], v[116:119], v[68:83]
    v_mul_f32 v216, v251, v216
    v_mul_f32 v217, v251, v217
    v_mul_f32 v218, v251, v218
    v_mul_f32 v219, v251, v219
    s_waitcnt lgkmcnt(6)
    v_mfma_f32_32x32x16_bf16 v[148:163], v[12:15], v[124:127], v[148:163]
    ds_read_b128 v[116:119], v232 offset:17408
    v_mul_f32 v220, v251, v220
    v_mul_f32 v221, v251, v221
    v_mul_f32 v222, v251, v222
    v_mul_f32 v223, v251, v223
    v_cvt_pk_bf16_f32 v32, v216, v217
    s_waitcnt lgkmcnt(6)
    v_mfma_f32_32x32x16_bf16 v[148:163], v[20:23], v[132:135], v[148:163]
    ds_read_b128 v[124:127], v232 offset:17472
    ds_read_b128 v[84:87], v249 offset:512
    v_cvt_pk_bf16_f32 v33, v218, v219
    v_cvt_pk_bf16_f32 v34, v220, v221
    v_cvt_pk_bf16_f32 v35, v222, v223
    v_mul_f32 v224, v251, v224
    v_mul_f32 v225, v251, v225
    s_waitcnt lgkmcnt(7)
    v_mfma_f32_32x32x16_bf16 v[148:163], v[28:31], v[140:143], v[148:163]
    ds_read_b128 v[132:135], v232 offset:17536
    ds_read_b128 v[88:91], v249 offset:544
    v_mul_f32 v226, v251, v226
    v_mul_f32 v227, v251, v227
    v_mul_f32 v228, v251, v228
    v_mul_f32 v229, v251, v229
    v_mul_f32 v230, v251, v230
    s_waitcnt lgkmcnt(7)
    v_mfma_f32_32x32x16_bf16 v[148:163], v[8:11], v[120:123], v[148:163]
    ds_read_b128 v[140:143], v232 offset:17600
    ds_read_b128 v[92:95], v249 offset:576
    v_mul_f32 v231, v251, v231
    v_cvt_pk_bf16_f32 v64, v224, v225
    v_cvt_pk_bf16_f32 v65, v226, v227
    v_cvt_pk_bf16_f32 v66, v228, v229
    v_cvt_pk_bf16_f32 v67, v230, v231
    s_waitcnt lgkmcnt(8)
    v_mfma_f32_32x32x16_bf16 v[148:163], v[16:19], v[128:131], v[148:163]
    ds_read_b128 v[120:123], v234 offset:17408
    ds_read_b128 v[96:99], v249 offset:608
    v_mov_b32 v251, 0x2b800000
    v_mov_b32 v250, 0
    v_mov_b32 v217, s78
    v_mov_b32 v208, 0
    v_mov_b32 v209, 0
    s_waitcnt lgkmcnt(9)
    v_mfma_f32_32x32x16_bf16 v[148:163], v[24:27], v[136:139], v[148:163]
    ds_read_b128 v[128:131], v234 offset:17472
    v_mov_b32 v210, 0
    v_mov_b32 v211, 0
    v_mov_b32 v212, 0
    v_mov_b32 v213, 0
    v_mov_b32 v214, 0
    v_mfma_f32_32x32x16_bf16 v[148:163], v[32:35], v[144:147], v[148:163]
    ds_read_b128 v[136:139], v234 offset:17536
    v_mov_b32 v215, 0
    ds_read_b128 v[144:147], v234 offset:17600
    s_waitcnt lgkmcnt(3)
    v_mfma_f32_32x32x16_bf16 v[164:179], v[36:39], v[116:119], v[84:99]
    v_mfma_f32_32x32x16_bf16 v[164:179], v[40:43], v[120:123], v[164:179]
    s_nop 5
    v_exp_f32_e64 v148, v148 clamp
    v_exp_f32_e64 v149, v149 clamp
    v_exp_f32_e64 v150, v150 clamp
    s_waitcnt lgkmcnt(2)
    v_mfma_f32_32x32x16_bf16 v[164:179], v[44:47], v[124:127], v[164:179]
    v_exp_f32_e64 v151, v151 clamp
    v_exp_f32_e64 v152, v152 clamp
    v_exp_f32_e64 v153, v153 clamp
    v_mfma_f32_32x32x16_bf16 v[164:179], v[48:51], v[128:131], v[164:179]
    v_exp_f32_e64 v154, v154 clamp
    v_exp_f32_e64 v155, v155 clamp
    v_exp_f32_e64 v156, v156 clamp
    s_waitcnt lgkmcnt(1)
    v_mfma_f32_32x32x16_bf16 v[164:179], v[52:55], v[132:135], v[164:179]
    v_exp_f32_e64 v157, v157 clamp
    v_exp_f32_e64 v158, v158 clamp
    v_exp_f32_e64 v159, v159 clamp
    v_mfma_f32_32x32x16_bf16 v[164:179], v[56:59], v[136:139], v[164:179]
    v_exp_f32_e64 v160, v160 clamp
    v_exp_f32_e64 v161, v161 clamp
    v_exp_f32_e64 v162, v162 clamp
    s_waitcnt lgkmcnt(0)
    v_mfma_f32_32x32x16_bf16 v[164:179], v[60:63], v[140:143], v[164:179]
    v_exp_f32_e64 v163, v163 clamp
    v_mfma_f32_32x32x16_bf16 v[164:179], v[64:67], v[144:147], v[164:179]
    s_setprio 2
    s_waitcnt vmcnt(1)
    s_barrier
    v_add_f32 v148, v251, v148
    v_add_f32 v149, v251, v149
    v_add_f32 v150, v251, v150
    v_add_f32 v151, v251, v151
    v_add_f32 v152, v251, v152
    v_add_f32 v153, v251, v153
    v_add_f32 v154, v251, v154
    v_add_f32 v155, v251, v155
    v_add_f32 v156, v251, v156
    v_add_f32 v157, v251, v157
    v_add_f32 v158, v251, v158
    v_add_f32 v159, v251, v159
    v_add_f32 v160, v251, v160
    v_add_f32 v161, v251, v161
    v_add_f32 v162, v251, v162
    v_add_f32 v163, v251, v163
    v_mul_f32 v180, v148, v149
    v_mul_f32 v181, v150, v151
    v_mul_f32 v182, v152, v153
    v_mul_f32 v183, v154, v155
    v_mul_f32 v184, v156, v157
    v_mul_f32 v185, v158, v159
    v_mul_f32 v186, v160, v161
    v_mul_f32 v187, v162, v163
    v_mul_f32 v188, v148, v101
    v_mul_f32 v189, v150, v103
    v_mul_f32 v190, v152, v105
    v_mul_f32 v191, v154, v107
    v_mul_f32 v192, v156, v109
    v_mul_f32 v193, v158, v111
    v_mul_f32 v194, v160, v113
    v_mul_f32 v195, v162, v115
    v_fmac_f32 v188, v149, v100
    v_fmac_f32 v189, v151, v102
    v_fmac_f32 v190, v153, v104
    v_fmac_f32 v191, v155, v106
    v_fmac_f32 v192, v157, v108
    v_fmac_f32 v193, v159, v110
    v_fmac_f32 v194, v161, v112
    v_fmac_f32 v195, v163, v114
    ds_read_b128 v[116:119], v232 offset:34816
    ds_read_b128 v[120:123], v234 offset:34816
    ds_read_b128 v[124:127], v232 offset:34880
    ds_read_b128 v[128:131], v234 offset:34880
    ds_read_b128 v[132:135], v232 offset:34944
    ds_read_b128 v[136:139], v234 offset:34944
    ds_read_b128 v[140:143], v232 offset:35008
    ds_read_b128 v[144:147], v234 offset:35008
    ds_read_u16_d16_hi v250, v246 offset:386
    s_setprio 0
    s_waitcnt lgkmcnt(7)
    v_mfma_f32_32x32x16_bf16 v[148:163], v[4:7], v[116:119], v[68:83]
    v_rcp_f32 v180, v180
    v_rcp_f32 v181, v181
    v_rcp_f32 v182, v182
    v_mfma_f32_32x32x16_bf16 v[148:163], v[8:11], v[120:123], v[148:163]
    v_rcp_f32 v183, v183
    v_rcp_f32 v184, v184
    v_rcp_f32 v185, v185
    s_waitcnt lgkmcnt(5)
    v_mfma_f32_32x32x16_bf16 v[148:163], v[12:15], v[124:127], v[148:163]
    v_rcp_f32 v186, v186
    v_rcp_f32 v187, v187
    v_exp_f32_e64 v164, v164 clamp
    v_mfma_f32_32x32x16_bf16 v[148:163], v[16:19], v[128:131], v[148:163]
    v_exp_f32_e64 v165, v165 clamp
    v_exp_f32_e64 v166, v166 clamp
    v_exp_f32_e64 v167, v167 clamp
    s_waitcnt lgkmcnt(3)
    v_mfma_f32_32x32x16_bf16 v[148:163], v[20:23], v[132:135], v[148:163]
    v_exp_f32_e64 v168, v168 clamp
    v_exp_f32_e64 v169, v169 clamp
    v_exp_f32_e64 v170, v170 clamp
    v_mfma_f32_32x32x16_bf16 v[148:163], v[24:27], v[136:139], v[148:163]
    v_exp_f32_e64 v171, v171 clamp
    v_exp_f32_e64 v172, v172 clamp
    v_exp_f32_e64 v173, v173 clamp
    s_waitcnt lgkmcnt(1)
    v_mfma_f32_32x32x16_bf16 v[148:163], v[28:31], v[140:143], v[148:163]
    v_exp_f32_e64 v174, v174 clamp
    v_exp_f32_e64 v175, v175 clamp
    v_exp_f32_e64 v176, v176 clamp
    v_mfma_f32_32x32x16_bf16 v[148:163], v[32:35], v[144:147], v[148:163]
    v_exp_f32_e64 v177, v177 clamp
    v_exp_f32_e64 v178, v178 clamp
    v_exp_f32_e64 v179, v179 clamp
    s_setprio 2
    s_waitcnt vmcnt(0)
    s_waitcnt lgkmcnt(0)
    s_barrier
    v_add_f32 v164, v251, v164
    v_fma_f32 v249, v188, v180, v248
    v_add_f32 v165, v251, v165
    v_add_f32 v166, v251, v166
    v_fmac_f32 v249, v189, v181
    v_add_f32 v167, v251, v167
    v_add_f32 v168, v251, v168
    v_fmac_f32 v249, v190, v182
    v_add_f32 v169, v251, v169
    v_add_f32 v170, v251, v170
    v_fmac_f32 v249, v191, v183
    v_add_f32 v171, v251, v171
    v_add_f32 v172, v251, v172
    v_fmac_f32 v249, v192, v184
    v_add_f32 v173, v251, v173
    v_add_f32 v174, v251, v174
    v_fmac_f32 v249, v193, v185
    v_add_f32 v175, v251, v175
    v_add_f32 v176, v251, v176
    v_fmac_f32 v249, v194, v186
    v_add_f32 v177, v251, v177
    v_add_f32 v178, v251, v178
    v_fmac_f32 v249, v195, v187
    v_add_f32 v179, v251, v179
    v_mul_f32 v252, v249, v250
    v_mul_f32 v180, v164, v165
    v_mul_f32 v181, v166, v167
    v_add_u32 v252, v217, v252
    v_mul_f32 v182, v168, v169
    v_mul_f32 v183, v170, v171
    v_mul_f32 v184, v172, v173
    v_mul_f32 v185, v174, v175
    v_mul_f32 v186, v176, v177
    v_mul_f32 v187, v178, v179
    v_mul_f32 v188, v164, v101
    v_mul_f32 v189, v166, v103
    v_mul_f32 v190, v168, v105
    v_mul_f32 v191, v170, v107
    v_mul_f32 v192, v172, v109
    v_mul_f32 v193, v174, v111
    v_mul_f32 v194, v176, v113
    v_mul_f32 v195, v178, v115
    v_fmac_f32 v188, v165, v100
    v_fmac_f32 v189, v167, v102
    v_fmac_f32 v190, v169, v104
    v_fmac_f32 v191, v171, v106
    v_fmac_f32 v192, v173, v108
    v_fmac_f32 v193, v175, v110
    v_fmac_f32 v194, v177, v112
    v_fmac_f32 v195, v179, v114
    ds_read_b128 v[116:119], v232 offset:52224
    ds_read_b128 v[120:123], v234 offset:52224
    ds_read_b128 v[124:127], v232 offset:52288
    ds_read_b128 v[128:131], v234 offset:52288
    ds_read_b128 v[132:135], v232 offset:52352
    ds_read_b128 v[136:139], v234 offset:52352
    ds_read_b128 v[140:143], v232 offset:52416
    ds_read_b128 v[144:147], v234 offset:52416
    ds_read_u16_d16_hi v250, v246 offset:1282
    ds_write_b16_d16_hi v244, v252 offset:0
    s_setprio 0
    s_waitcnt lgkmcnt(8)
    v_mfma_f32_32x32x16_bf16 v[164:179], v[4:7], v[116:119], v[68:83]
    v_rcp_f32 v180, v180
    v_rcp_f32 v181, v181
    v_rcp_f32 v182, v182
    v_mfma_f32_32x32x16_bf16 v[164:179], v[8:11], v[120:123], v[164:179]
    v_rcp_f32 v183, v183
    v_rcp_f32 v184, v184
    v_rcp_f32 v185, v185
    s_waitcnt lgkmcnt(6)
    v_mfma_f32_32x32x16_bf16 v[164:179], v[12:15], v[124:127], v[164:179]
    v_rcp_f32 v186, v186
    v_rcp_f32 v187, v187
    v_exp_f32_e64 v148, v148 clamp
    v_mfma_f32_32x32x16_bf16 v[164:179], v[16:19], v[128:131], v[164:179]
    v_exp_f32_e64 v149, v149 clamp
    v_exp_f32_e64 v150, v150 clamp
    v_exp_f32_e64 v151, v151 clamp
    s_waitcnt lgkmcnt(4)
    v_mfma_f32_32x32x16_bf16 v[164:179], v[20:23], v[132:135], v[164:179]
    v_exp_f32_e64 v152, v152 clamp
    v_exp_f32_e64 v153, v153 clamp
    v_exp_f32_e64 v154, v154 clamp
    v_mfma_f32_32x32x16_bf16 v[164:179], v[24:27], v[136:139], v[164:179]
    v_exp_f32_e64 v155, v155 clamp
    v_exp_f32_e64 v156, v156 clamp
    v_exp_f32_e64 v157, v157 clamp
    s_waitcnt lgkmcnt(2)
    v_mfma_f32_32x32x16_bf16 v[164:179], v[28:31], v[140:143], v[164:179]
    v_exp_f32_e64 v158, v158 clamp
    v_exp_f32_e64 v159, v159 clamp
    v_exp_f32_e64 v160, v160 clamp
    v_mfma_f32_32x32x16_bf16 v[164:179], v[32:35], v[144:147], v[164:179]
    v_exp_f32_e64 v161, v161 clamp
    v_exp_f32_e64 v162, v162 clamp
    v_exp_f32_e64 v163, v163 clamp
    s_setprio 2
    s_waitcnt lgkmcnt(0)
    s_barrier
    v_add_f32 v148, v251, v148
    v_fma_f32 v249, v188, v180, v248
    v_add_f32 v149, v251, v149
    v_add_f32 v150, v251, v150
    v_fmac_f32 v249, v189, v181
    v_add_f32 v151, v251, v151
    v_add_f32 v152, v251, v152
    v_fmac_f32 v249, v190, v182
    v_add_f32 v153, v251, v153
    v_add_f32 v154, v251, v154
    v_fmac_f32 v249, v191, v183
    v_add_f32 v155, v251, v155
    v_add_f32 v156, v251, v156
    v_fmac_f32 v249, v192, v184
    v_add_f32 v157, v251, v157
    v_add_f32 v158, v251, v158
    v_fmac_f32 v249, v193, v185
    v_add_f32 v159, v251, v159
    v_add_f32 v160, v251, v160
    v_fmac_f32 v249, v194, v186
    v_add_f32 v161, v251, v161
    v_add_f32 v162, v251, v162
    v_fmac_f32 v249, v195, v187
    v_add_f32 v163, v251, v163
    v_mul_f32 v252, v249, v250
    v_mul_f32 v180, v148, v149
    v_mul_f32 v181, v150, v151
    v_add_u32 v252, v217, v252
    v_mul_f32 v182, v152, v153
    v_mul_f32 v183, v154, v155
    v_mul_f32 v184, v156, v157
    v_mul_f32 v185, v158, v159
    v_mul_f32 v186, v160, v161
    v_mul_f32 v187, v162, v163
    v_mul_f32 v188, v148, v101
    v_mul_f32 v189, v150, v103
    v_mul_f32 v190, v152, v105
    v_mul_f32 v191, v154, v107
    v_mul_f32 v192, v156, v109
    v_mul_f32 v193, v158, v111
    v_mul_f32 v194, v160, v113
    v_mul_f32 v195, v162, v115
    v_fmac_f32 v188, v149, v100
    v_fmac_f32 v189, v151, v102
    v_fmac_f32 v190, v153, v104
    v_fmac_f32 v191, v155, v106
    v_fmac_f32 v192, v157, v108
    v_fmac_f32 v193, v159, v110
    v_fmac_f32 v194, v161, v112
    v_fmac_f32 v195, v163, v114
    ds_read_b128 v[116:119], v233 offset:0
    ds_read_b128 v[120:123], v235 offset:0
    ds_read_b128 v[124:127], v233 offset:64
    ds_read_b128 v[128:131], v235 offset:64
    ds_read_b128 v[132:135], v233 offset:128
    ds_read_b128 v[136:139], v235 offset:128
    ds_read_b128 v[140:143], v233 offset:192
    ds_read_b128 v[144:147], v235 offset:192
    ds_read_b128 v[196:199], v245 offset:0
    ds_read_b64_tr_b16 v[200:201], v236 offset:0
    ds_read_b64_tr_b16 v[202:203], v237 offset:256
    ds_read_b64_tr_b16 v[204:205], v238 offset:0
    ds_read_b64_tr_b16 v[206:207], v239 offset:256
    ds_read_u16_d16_hi v250, v246 offset:514
    ds_write_b16_d16_hi v247, v252 offset:1024
    s_setprio 0
    v_rcp_f32 v180, v180
    v_rcp_f32 v181, v181
    s_waitcnt lgkmcnt(13)
    v_mfma_f32_32x32x16_bf16 v[148:163], v[4:7], v[116:119], v[68:83]
    v_rcp_f32 v182, v182
    v_rcp_f32 v183, v183
    v_rcp_f32 v184, v184
    v_mfma_f32_32x32x16_bf16 v[148:163], v[8:11], v[120:123], v[148:163]
    v_rcp_f32 v185, v185
    v_rcp_f32 v186, v186
    v_rcp_f32 v187, v187
    s_waitcnt lgkmcnt(11)
    v_mfma_f32_32x32x16_bf16 v[148:163], v[12:15], v[124:127], v[148:163]
    v_exp_f32_e64 v164, v164 clamp
    v_exp_f32_e64 v165, v165 clamp
    v_exp_f32_e64 v166, v166 clamp
    v_mfma_f32_32x32x16_bf16 v[148:163], v[16:19], v[128:131], v[148:163]
    v_exp_f32_e64 v167, v167 clamp
    v_exp_f32_e64 v168, v168 clamp
    v_exp_f32_e64 v169, v169 clamp
    s_waitcnt lgkmcnt(9)
    v_mfma_f32_32x32x16_bf16 v[148:163], v[20:23], v[132:135], v[148:163]
    v_exp_f32_e64 v170, v170 clamp
    v_exp_f32_e64 v171, v171 clamp
    v_exp_f32_e64 v172, v172 clamp
    v_mfma_f32_32x32x16_bf16 v[148:163], v[24:27], v[136:139], v[148:163]
    v_exp_f32_e64 v173, v173 clamp
    v_exp_f32_e64 v174, v174 clamp
    v_exp_f32_e64 v175, v175 clamp
    s_waitcnt lgkmcnt(2)
    v_mfma_f32_16x16x32_bf16 v[208:211], v[196:199], v[200:203], v[208:211]
    v_exp_f32_e64 v176, v176 clamp
    v_mfma_f32_16x16x32_bf16 v[212:215], v[196:199], v[204:207], v[212:215]
    v_exp_f32_e64 v177, v177 clamp
    v_mfma_f32_32x32x16_bf16 v[148:163], v[28:31], v[140:143], v[148:163]
    v_exp_f32_e64 v178, v178 clamp
    v_exp_f32_e64 v179, v179 clamp
    v_mfma_f32_32x32x16_bf16 v[148:163], v[32:35], v[144:147], v[148:163]
    s_setprio 2
    s_waitcnt lgkmcnt(0)
    s_barrier
    v_add_f32 v164, v251, v164
    v_fma_f32 v249, v188, v180, v248
    v_add_f32 v165, v251, v165
    v_add_f32 v166, v251, v166
    v_fmac_f32 v249, v189, v181
    v_add_f32 v167, v251, v167
    v_add_f32 v168, v251, v168
    v_fmac_f32 v249, v190, v182
    v_add_f32 v169, v251, v169
    v_add_f32 v170, v251, v170
    v_fmac_f32 v249, v191, v183
    v_add_f32 v171, v251, v171
    v_add_f32 v172, v251, v172
    v_fmac_f32 v249, v192, v184
    v_add_f32 v173, v251, v173
    v_add_f32 v174, v251, v174
    v_fmac_f32 v249, v193, v185
    v_add_f32 v175, v251, v175
    v_add_f32 v176, v251, v176
    v_fmac_f32 v249, v194, v186
    v_add_f32 v177, v251, v177
    v_add_f32 v178, v251, v178
    v_fmac_f32 v249, v195, v187
    v_add_f32 v179, v251, v179
    v_mul_f32 v252, v249, v250
    v_mul_f32 v180, v164, v165
    v_mul_f32 v181, v166, v167
    v_add_u32 v252, v217, v252
    v_mul_f32 v182, v168, v169
    v_mul_f32 v183, v170, v171
    v_mul_f32 v184, v172, v173
    v_mul_f32 v185, v174, v175
    v_mul_f32 v186, v176, v177
    v_mul_f32 v187, v178, v179
    v_mul_f32 v188, v164, v101
    v_mul_f32 v189, v166, v103
    v_mul_f32 v190, v168, v105
    v_mul_f32 v191, v170, v107
    v_mul_f32 v192, v172, v109
    v_mul_f32 v193, v174, v111
    v_mul_f32 v194, v176, v113
    v_mul_f32 v195, v178, v115
    v_fmac_f32 v188, v165, v100
    v_fmac_f32 v189, v167, v102
    v_fmac_f32 v190, v169, v104
    v_fmac_f32 v191, v171, v106
    v_fmac_f32 v192, v173, v108
    v_fmac_f32 v193, v175, v110
    v_fmac_f32 v194, v177, v112
    v_fmac_f32 v195, v179, v114
    ds_read_b128 v[116:119], v233 offset:17408
    ds_read_b128 v[120:123], v235 offset:17408
    ds_read_b128 v[124:127], v233 offset:17472
    ds_read_b128 v[128:131], v235 offset:17472
    ds_read_b128 v[132:135], v233 offset:17536
    ds_read_b128 v[136:139], v235 offset:17536
    ds_read_b128 v[140:143], v233 offset:17600
    ds_read_b128 v[144:147], v235 offset:17600
    ds_read_b128 v[196:199], v245 offset:512
    ds_read_b64_tr_b16 v[200:201], v236 offset:17408
    ds_read_b64_tr_b16 v[202:203], v237 offset:17664
    ds_read_b64_tr_b16 v[204:205], v238 offset:17408
    ds_read_b64_tr_b16 v[206:207], v239 offset:17664
    ds_read_u16_d16_hi v250, v246 offset:642
    ds_write_b16_d16_hi v244, v252 offset:2560
    s_setprio 0
    v_rcp_f32 v180, v180
    v_rcp_f32 v181, v181
    s_waitcnt lgkmcnt(13)
    v_mfma_f32_32x32x16_bf16 v[164:179], v[36:39], v[116:119], v[84:99]
    v_rcp_f32 v182, v182
    v_rcp_f32 v183, v183
    v_rcp_f32 v184, v184
    v_mfma_f32_32x32x16_bf16 v[164:179], v[40:43], v[120:123], v[164:179]
    v_rcp_f32 v185, v185
    v_rcp_f32 v186, v186
    v_rcp_f32 v187, v187
    s_waitcnt lgkmcnt(11)
    v_mfma_f32_32x32x16_bf16 v[164:179], v[44:47], v[124:127], v[164:179]
    v_exp_f32_e64 v148, v148 clamp
    v_exp_f32_e64 v149, v149 clamp
    v_exp_f32_e64 v150, v150 clamp
    v_mfma_f32_32x32x16_bf16 v[164:179], v[48:51], v[128:131], v[164:179]
    v_exp_f32_e64 v151, v151 clamp
    v_exp_f32_e64 v152, v152 clamp
    v_exp_f32_e64 v153, v153 clamp
    s_waitcnt lgkmcnt(9)
    v_mfma_f32_32x32x16_bf16 v[164:179], v[52:55], v[132:135], v[164:179]
    v_exp_f32_e64 v154, v154 clamp
    v_exp_f32_e64 v155, v155 clamp
    v_exp_f32_e64 v156, v156 clamp
    v_mfma_f32_32x32x16_bf16 v[164:179], v[56:59], v[136:139], v[164:179]
    v_exp_f32_e64 v157, v157 clamp
    v_exp_f32_e64 v158, v158 clamp
    v_exp_f32_e64 v159, v159 clamp
    s_waitcnt lgkmcnt(2)
    v_mfma_f32_16x16x32_bf16 v[208:211], v[196:199], v[200:203], v[208:211]
    v_exp_f32_e64 v160, v160 clamp
    v_mfma_f32_16x16x32_bf16 v[212:215], v[196:199], v[204:207], v[212:215]
    v_exp_f32_e64 v161, v161 clamp
    v_mfma_f32_32x32x16_bf16 v[164:179], v[60:63], v[140:143], v[164:179]
    v_exp_f32_e64 v162, v162 clamp
    v_exp_f32_e64 v163, v163 clamp
    v_mfma_f32_32x32x16_bf16 v[164:179], v[64:67], v[144:147], v[164:179]
    s_setprio 2
    s_waitcnt lgkmcnt(0)
    s_barrier
    v_add_f32 v148, v251, v148
    v_fma_f32 v249, v188, v180, v248
    v_add_f32 v149, v251, v149
    v_add_f32 v150, v251, v150
    v_fmac_f32 v249, v189, v181
    v_add_f32 v151, v251, v151
    v_add_f32 v152, v251, v152
    v_fmac_f32 v249, v190, v182
    v_add_f32 v153, v251, v153
    v_add_f32 v154, v251, v154
    v_fmac_f32 v249, v191, v183
    v_add_f32 v155, v251, v155
    v_add_f32 v156, v251, v156
    v_fmac_f32 v249, v192, v184
    v_add_f32 v157, v251, v157
    v_add_f32 v158, v251, v158
    v_fmac_f32 v249, v193, v185
    v_add_f32 v159, v251, v159
    v_add_f32 v160, v251, v160
    v_fmac_f32 v249, v194, v186
    v_add_f32 v161, v251, v161
    v_add_f32 v162, v251, v162
    v_fmac_f32 v249, v195, v187
    v_add_f32 v163, v251, v163
    v_mul_f32 v252, v249, v250
    v_mul_f32 v180, v148, v149
    v_mul_f32 v181, v150, v151
    v_add_u32 v252, v217, v252
    v_mul_f32 v182, v152, v153
    v_mul_f32 v183, v154, v155
    v_mul_f32 v184, v156, v157
    v_mul_f32 v185, v158, v159
    v_mul_f32 v186, v160, v161
    v_mul_f32 v187, v162, v163
    v_mul_f32 v188, v148, v101
    v_mul_f32 v189, v150, v103
    v_mul_f32 v190, v152, v105
    v_mul_f32 v191, v154, v107
    v_mul_f32 v192, v156, v109
    v_mul_f32 v193, v158, v111
    v_mul_f32 v194, v160, v113
    v_mul_f32 v195, v162, v115
    v_fmac_f32 v188, v149, v100
    v_fmac_f32 v189, v151, v102
    v_fmac_f32 v190, v153, v104
    v_fmac_f32 v191, v155, v106
    v_fmac_f32 v192, v157, v108
    v_fmac_f32 v193, v159, v110
    v_fmac_f32 v194, v161, v112
    v_fmac_f32 v195, v163, v114
    ds_read_b128 v[116:119], v233 offset:34816
    ds_read_b128 v[120:123], v235 offset:34816
    ds_read_b128 v[124:127], v233 offset:34880
    ds_read_b128 v[128:131], v235 offset:34880
    ds_read_b128 v[132:135], v233 offset:34944
    ds_read_b128 v[136:139], v235 offset:34944
    ds_read_b128 v[140:143], v233 offset:35008
    ds_read_b128 v[144:147], v235 offset:35008
    ds_read_b128 v[196:199], v245 offset:2560
    ds_read_b64_tr_b16 v[200:201], v236 offset:34816
    ds_read_b64_tr_b16 v[202:203], v237 offset:35072
    ds_read_b64_tr_b16 v[204:205], v238 offset:34816
    ds_read_b64_tr_b16 v[206:207], v239 offset:35072
    ds_read_u16_d16_hi v250, v246 offset:770
    ds_write_b16_d16_hi v244, v252 offset:1536
    s_setprio 0
    v_rcp_f32 v180, v180
    v_rcp_f32 v181, v181
    s_waitcnt lgkmcnt(13)
    v_mfma_f32_32x32x16_bf16 v[148:163], v[36:39], v[116:119], v[84:99]
    v_rcp_f32 v182, v182
    v_rcp_f32 v183, v183
    v_rcp_f32 v184, v184
    v_mfma_f32_32x32x16_bf16 v[148:163], v[40:43], v[120:123], v[148:163]
    v_rcp_f32 v185, v185
    v_rcp_f32 v186, v186
    v_rcp_f32 v187, v187
    s_waitcnt lgkmcnt(11)
    v_mfma_f32_32x32x16_bf16 v[148:163], v[44:47], v[124:127], v[148:163]
    v_exp_f32_e64 v164, v164 clamp
    v_exp_f32_e64 v165, v165 clamp
    v_exp_f32_e64 v166, v166 clamp
    v_mfma_f32_32x32x16_bf16 v[148:163], v[48:51], v[128:131], v[148:163]
    v_exp_f32_e64 v167, v167 clamp
    v_exp_f32_e64 v168, v168 clamp
    v_exp_f32_e64 v169, v169 clamp
    s_waitcnt lgkmcnt(9)
    v_mfma_f32_32x32x16_bf16 v[148:163], v[52:55], v[132:135], v[148:163]
    v_exp_f32_e64 v170, v170 clamp
    v_exp_f32_e64 v171, v171 clamp
    v_exp_f32_e64 v172, v172 clamp
    v_mfma_f32_32x32x16_bf16 v[148:163], v[56:59], v[136:139], v[148:163]
    v_exp_f32_e64 v173, v173 clamp
    v_exp_f32_e64 v174, v174 clamp
    v_exp_f32_e64 v175, v175 clamp
    s_waitcnt lgkmcnt(2)
    v_mfma_f32_16x16x32_bf16 v[208:211], v[196:199], v[200:203], v[208:211]
    v_exp_f32_e64 v176, v176 clamp
    v_mfma_f32_16x16x32_bf16 v[212:215], v[196:199], v[204:207], v[212:215]
    v_exp_f32_e64 v177, v177 clamp
    v_mfma_f32_32x32x16_bf16 v[148:163], v[60:63], v[140:143], v[148:163]
    v_exp_f32_e64 v178, v178 clamp
    v_exp_f32_e64 v179, v179 clamp
    v_mfma_f32_32x32x16_bf16 v[148:163], v[64:67], v[144:147], v[148:163]
    s_setprio 2
    s_waitcnt lgkmcnt(0)
    s_barrier
    v_add_f32 v164, v251, v164
    v_fma_f32 v249, v188, v180, v248
    v_add_f32 v165, v251, v165
    v_add_f32 v166, v251, v166
    v_fmac_f32 v249, v189, v181
    v_add_f32 v167, v251, v167
    v_add_f32 v168, v251, v168
    v_fmac_f32 v249, v190, v182
    v_add_f32 v169, v251, v169
    v_add_f32 v170, v251, v170
    v_fmac_f32 v249, v191, v183
    v_add_f32 v171, v251, v171
    v_add_f32 v172, v251, v172
    v_fmac_f32 v249, v192, v184
    v_add_f32 v173, v251, v173
    v_add_f32 v174, v251, v174
    v_fmac_f32 v249, v193, v185
    v_add_f32 v175, v251, v175
    v_add_f32 v176, v251, v176
    v_fmac_f32 v249, v194, v186
    v_add_f32 v177, v251, v177
    v_add_f32 v178, v251, v178
    v_fmac_f32 v249, v195, v187
    v_add_f32 v179, v251, v179
    v_mul_f32 v252, v249, v250
    v_mul_f32 v180, v164, v165
    v_mul_f32 v181, v166, v167
    v_add_u32 v252, v217, v252
    v_mul_f32 v182, v168, v169
    v_mul_f32 v183, v170, v171
    v_mul_f32 v184, v172, v173
    v_mul_f32 v185, v174, v175
    v_mul_f32 v186, v176, v177
    v_mul_f32 v187, v178, v179
    v_mul_f32 v188, v164, v101
    v_mul_f32 v189, v166, v103
    v_mul_f32 v190, v168, v105
    v_mul_f32 v191, v170, v107
    v_mul_f32 v192, v172, v109
    v_mul_f32 v193, v174, v111
    v_mul_f32 v194, v176, v113
    v_mul_f32 v195, v178, v115
    v_fmac_f32 v188, v165, v100
    v_fmac_f32 v189, v167, v102
    v_fmac_f32 v190, v169, v104
    v_fmac_f32 v191, v171, v106
    v_fmac_f32 v192, v173, v108
    v_fmac_f32 v193, v175, v110
    v_fmac_f32 v194, v177, v112
    v_fmac_f32 v195, v179, v114
    ds_read_b128 v[116:119], v233 offset:52224
    ds_read_b128 v[120:123], v235 offset:52224
    ds_read_b128 v[124:127], v233 offset:52288
    ds_read_b128 v[128:131], v235 offset:52288
    ds_read_b128 v[132:135], v233 offset:52352
    ds_read_b128 v[136:139], v235 offset:52352
    ds_read_b128 v[140:143], v233 offset:52416
    ds_read_b128 v[144:147], v235 offset:52416
    ds_read_b128 v[196:199], v245 offset:1536
    ds_read_b64_tr_b16 v[200:201], v236 offset:52224
    ds_read_b64_tr_b16 v[202:203], v237 offset:52480
    ds_read_b64_tr_b16 v[204:205], v238 offset:52224
    ds_read_b64_tr_b16 v[206:207], v239 offset:52480
    ds_read_u16_d16_hi v250, v246 offset:1410
    ds_write_b16_d16_hi v244, v252 offset:0
    s_setprio 0
    v_rcp_f32 v180, v180
    v_rcp_f32 v181, v181
    s_waitcnt lgkmcnt(13)
    v_mfma_f32_32x32x16_bf16 v[164:179], v[36:39], v[116:119], v[84:99]
    v_rcp_f32 v182, v182
    v_rcp_f32 v183, v183
    v_rcp_f32 v184, v184
    v_mfma_f32_32x32x16_bf16 v[164:179], v[40:43], v[120:123], v[164:179]
    v_rcp_f32 v185, v185
    v_rcp_f32 v186, v186
    v_rcp_f32 v187, v187
    s_waitcnt lgkmcnt(11)
    v_mfma_f32_32x32x16_bf16 v[164:179], v[44:47], v[124:127], v[164:179]
    v_exp_f32_e64 v148, v148 clamp
    v_exp_f32_e64 v149, v149 clamp
    v_exp_f32_e64 v150, v150 clamp
    v_mfma_f32_32x32x16_bf16 v[164:179], v[48:51], v[128:131], v[164:179]
    v_exp_f32_e64 v151, v151 clamp
    v_exp_f32_e64 v152, v152 clamp
    v_exp_f32_e64 v153, v153 clamp
    s_waitcnt lgkmcnt(9)
    v_mfma_f32_32x32x16_bf16 v[164:179], v[52:55], v[132:135], v[164:179]
    v_exp_f32_e64 v154, v154 clamp
    v_exp_f32_e64 v155, v155 clamp
    v_exp_f32_e64 v156, v156 clamp
    v_mfma_f32_32x32x16_bf16 v[164:179], v[56:59], v[136:139], v[164:179]
    v_exp_f32_e64 v157, v157 clamp
    v_exp_f32_e64 v158, v158 clamp
    v_exp_f32_e64 v159, v159 clamp
    s_waitcnt lgkmcnt(2)
    v_mfma_f32_16x16x32_bf16 v[208:211], v[196:199], v[200:203], v[208:211]
    v_exp_f32_e64 v160, v160 clamp
    v_mfma_f32_16x16x32_bf16 v[212:215], v[196:199], v[204:207], v[212:215]
    v_exp_f32_e64 v161, v161 clamp
    v_mfma_f32_32x32x16_bf16 v[164:179], v[60:63], v[140:143], v[164:179]
    v_exp_f32_e64 v162, v162 clamp
    v_exp_f32_e64 v163, v163 clamp
    v_mfma_f32_32x32x16_bf16 v[164:179], v[64:67], v[144:147], v[164:179]
    s_setprio 2
    s_waitcnt lgkmcnt(0)
    s_barrier
    v_add_f32 v148, v251, v148
    v_fma_f32 v249, v188, v180, v248
    v_add_f32 v149, v251, v149
    v_add_f32 v150, v251, v150
    v_fmac_f32 v249, v189, v181
    v_add_f32 v151, v251, v151
    v_add_f32 v152, v251, v152
    v_fmac_f32 v249, v190, v182
    v_add_f32 v153, v251, v153
    v_add_f32 v154, v251, v154
    v_fmac_f32 v249, v191, v183
    v_add_f32 v155, v251, v155
    v_add_f32 v156, v251, v156
    v_fmac_f32 v249, v192, v184
    v_add_f32 v157, v251, v157
    v_add_f32 v158, v251, v158
    v_fmac_f32 v249, v193, v185
    v_add_f32 v159, v251, v159
    v_add_f32 v160, v251, v160
    v_fmac_f32 v249, v194, v186
    v_add_f32 v161, v251, v161
    v_add_f32 v162, v251, v162
    v_fmac_f32 v249, v195, v187
    v_add_f32 v163, v251, v163
    v_mul_f32 v252, v249, v250
    v_mul_f32 v180, v148, v149
    v_mul_f32 v181, v150, v151
    v_add_u32 v252, v217, v252
    v_mul_f32 v182, v152, v153
    v_mul_f32 v183, v154, v155
    v_mul_f32 v184, v156, v157
    v_mul_f32 v185, v158, v159
    v_mul_f32 v186, v160, v161
    v_mul_f32 v187, v162, v163
    v_mul_f32 v188, v148, v101
    v_mul_f32 v189, v150, v103
    v_mul_f32 v190, v152, v105
    v_mul_f32 v191, v154, v107
    v_mul_f32 v192, v156, v109
    v_mul_f32 v193, v158, v111
    v_mul_f32 v194, v160, v113
    v_mul_f32 v195, v162, v115
    v_fmac_f32 v188, v149, v100
    v_fmac_f32 v189, v151, v102
    v_fmac_f32 v190, v153, v104
    v_fmac_f32 v191, v155, v106
    v_fmac_f32 v192, v157, v108
    v_fmac_f32 v193, v159, v110
    v_fmac_f32 v194, v161, v112
    v_fmac_f32 v195, v163, v114
    ds_read_b128 v[196:199], v245 offset:0
    ds_read_b64_tr_b16 v[200:201], v240 offset:0
    ds_read_b64_tr_b16 v[202:203], v241 offset:256
    ds_read_b64_tr_b16 v[204:205], v242 offset:0
    ds_read_b64_tr_b16 v[206:207], v243 offset:256
    ds_read_u16_d16_hi v250, v246 offset:1538
    ds_read_b64_tr_b16 v[120:121], v240 offset:17408
    ds_read_b64_tr_b16 v[122:123], v241 offset:17664
    ds_read_b64_tr_b16 v[124:125], v242 offset:17408
    ds_read_b64_tr_b16 v[126:127], v243 offset:17664
    ds_read_b64_tr_b16 v[132:133], v240 offset:34816
    ds_read_b64_tr_b16 v[134:135], v241 offset:35072
    ds_read_b64_tr_b16 v[136:137], v242 offset:34816
    ds_read_b64_tr_b16 v[138:139], v243 offset:35072
    ds_write_b16_d16_hi v247, v252 offset:2560
    s_setprio 0
    v_rcp_f32 v180, v180
    v_rcp_f32 v181, v181
    v_rcp_f32 v182, v182
    v_rcp_f32 v183, v183
    v_rcp_f32 v184, v184
    v_rcp_f32 v185, v185
    v_rcp_f32 v186, v186
    v_rcp_f32 v187, v187
    v_exp_f32_e64 v164, v164 clamp
    v_exp_f32_e64 v165, v165 clamp
    v_exp_f32_e64 v166, v166 clamp
    v_exp_f32_e64 v167, v167 clamp
    v_exp_f32_e64 v168, v168 clamp
    v_exp_f32_e64 v169, v169 clamp
    v_exp_f32_e64 v170, v170 clamp
    v_exp_f32_e64 v171, v171 clamp
    v_exp_f32_e64 v172, v172 clamp
    v_exp_f32_e64 v173, v173 clamp
    v_exp_f32_e64 v174, v174 clamp
    v_exp_f32_e64 v175, v175 clamp
    v_exp_f32_e64 v176, v176 clamp
    s_waitcnt lgkmcnt(10)
    v_mfma_f32_16x16x32_bf16 v[208:211], v[196:199], v[200:203], v[208:211]
    v_exp_f32_e64 v177, v177 clamp
    v_mfma_f32_16x16x32_bf16 v[212:215], v[196:199], v[204:207], v[212:215]
    v_exp_f32_e64 v178, v178 clamp
    v_exp_f32_e64 v179, v179 clamp
    s_setprio 2
    s_waitcnt lgkmcnt(0)
    s_barrier
    v_add_f32 v164, v251, v164
    v_fma_f32 v249, v188, v180, v248
    v_add_f32 v165, v251, v165
    v_add_f32 v166, v251, v166
    v_fmac_f32 v249, v189, v181
    v_add_f32 v167, v251, v167
    v_add_f32 v168, v251, v168
    v_fmac_f32 v249, v190, v182
    v_add_f32 v169, v251, v169
    v_add_f32 v170, v251, v170
    v_fmac_f32 v249, v191, v183
    v_add_f32 v171, v251, v171
    v_add_f32 v172, v251, v172
    v_fmac_f32 v249, v192, v184
    v_add_f32 v173, v251, v173
    v_add_f32 v174, v251, v174
    v_fmac_f32 v249, v193, v185
    v_add_f32 v175, v251, v175
    v_add_f32 v176, v251, v176
    v_fmac_f32 v249, v194, v186
    v_add_f32 v177, v251, v177
    v_add_f32 v178, v251, v178
    v_fmac_f32 v249, v195, v187
    v_add_f32 v179, v251, v179
    v_mul_f32 v252, v249, v250
    v_mul_f32 v180, v164, v165
    v_mul_f32 v181, v166, v167
    v_add_u32 v252, v217, v252
    v_mul_f32 v182, v168, v169
    v_mul_f32 v183, v170, v171
    v_mul_f32 v184, v172, v173
    v_mul_f32 v185, v174, v175
    v_mul_f32 v186, v176, v177
    v_mul_f32 v187, v178, v179
    v_mul_f32 v188, v164, v101
    v_mul_f32 v189, v166, v103
    v_mul_f32 v190, v168, v105
    v_mul_f32 v191, v170, v107
    v_mul_f32 v192, v172, v109
    v_mul_f32 v193, v174, v111
    v_mul_f32 v194, v176, v113
    v_mul_f32 v195, v178, v115
    v_fmac_f32 v188, v165, v100
    v_fmac_f32 v189, v167, v102
    v_fmac_f32 v190, v169, v104
    v_fmac_f32 v191, v171, v106
    v_fmac_f32 v192, v173, v108
    v_fmac_f32 v193, v175, v110
    v_fmac_f32 v194, v177, v112
    v_fmac_f32 v195, v179, v114
    ds_read_u16_d16_hi v250, v246 offset:1666
    ds_read_b128 v[116:119], v245 offset:2048
    ds_read_b64_tr_b16 v[140:141], v240 offset:52224
    ds_read_b64_tr_b16 v[142:143], v241 offset:52480
    ds_read_b64_tr_b16 v[144:145], v242 offset:52224
    ds_read_b64_tr_b16 v[146:147], v243 offset:52480
    ds_write_b16_d16_hi v247, v252 offset:1024
    v_rcp_f32 v180, v180
    v_rcp_f32 v181, v181
    v_rcp_f32 v182, v182
    v_rcp_f32 v183, v183
    v_rcp_f32 v184, v184
    v_rcp_f32 v185, v185
    v_rcp_f32 v186, v186
    v_rcp_f32 v187, v187
    v_fma_f32 v249, v188, v180, v248
    v_mul_f32 v248, v189, v181
    v_fmac_f32 v249, v190, v182
    v_fmac_f32 v248, v191, v183
    v_fmac_f32 v249, v192, v184
    v_fmac_f32 v248, v193, v185
    v_fmac_f32 v249, v194, v186
    v_fmac_f32 v248, v195, v187
    v_add_f32 v249, v249, v248
    s_waitcnt lgkmcnt(6)
    v_mul_f32 v249, v249, v250
    v_add_u32 v249, s78, v249
    ds_write_b16_d16_hi v247, v249 offset:3584
    s_waitcnt lgkmcnt(2)
    v_mfma_f32_16x16x32_bf16 v[208:211], v[116:119], v[120:123], v[208:211]
    v_mfma_f32_16x16x32_bf16 v[212:215], v[116:119], v[124:127], v[212:215]
    v_mbcnt_lo_u32_b32 v0, -1, 0
    v_mbcnt_hi_u32_b32 v0, -1, v0
    s_lshl_b32 s31, s29, 9
    v_and_b32 v1, 32, v0
    s_lshl_b32 s32, s30, 6
    v_mul_u32_u24 v1, 6, v1
    s_add_u32 s31, s31, s32
    v_lshl_add_u32 v0, v0, 1, v1
    v_add_u32 v0, s31, v0
    s_waitcnt lgkmcnt(0)
    s_barrier
    ds_read_b128 v[128:131], v245 offset:512
    ds_read_b128 v[196:199], v245 offset:3072
    s_waitcnt lgkmcnt(1)
    v_mfma_f32_16x16x32_bf16 v[208:211], v[128:131], v[132:135], v[208:211]
    v_mfma_f32_16x16x32_bf16 v[212:215], v[128:131], v[136:139], v[212:215]
    s_waitcnt lgkmcnt(0)
    v_mfma_f32_16x16x32_bf16 v[208:211], v[196:199], v[140:143], v[208:211]
    v_mfma_f32_16x16x32_bf16 v[212:215], v[196:199], v[144:147], v[212:215]
L_epi:
    s_nop 6
    v_add_f32 v208, v208, v209
    v_add_f32 v210, v210, v211
    v_add_f32 v212, v212, v213
    v_add_f32 v214, v214, v215
    v_add_f32 v208, v208, v210
    v_add_f32 v212, v212, v214
    s_nop 1
    v_permlane16_swap_b32 v208, v212
    s_nop 1
    v_add_f32 v208, v208, v212
    v_mul_f32 v208, v251, v208
    v_cvt_pk_bf16_f32 v208, v208, v208
    global_store_short v0, v208, s[18:19]
    s_endpgm
L_exit:
    s_endpgm
L_slow:
    s_mul_i32 s31, s29, 1856
    s_lshl_b32 s32, s30, 4
    s_add_u32 s31, s31, s32
    s_sub_u32 s31, s31, 64
    v_add_u32 v253, s31, v253
    v_mbcnt_lo_u32_b32 v1, -1, 0
    v_min_u32 v1, 13, v1
    s_mul_i32 s31, s29, 1792
    s_add_u32 s31, s31, 156796
    v_lshl_add_u32 v1, v1, 7, s31
    ds_read_u16 v1, v1
    s_waitcnt lgkmcnt(0)
    v_cmp_gt_u32 vcc, s78, v1
    v_mov_b32 v250, 0
    ds_read_b128 v[68:71], v249 offset:0
    ds_read_b128 v[72:75], v249 offset:32
    ds_read_b128 v[76:79], v249 offset:64
    ds_read_b128 v[80:83], v249 offset:96
    ds_read_b128 v[84:87], v249 offset:512
    ds_read_b128 v[88:91], v249 offset:544
    ds_read_b128 v[92:95], v249 offset:576
    ds_read_b128 v[96:99], v249 offset:608
    v_mul_f32 v216, v251, v216
    v_mul_f32 v217, v251, v217
    v_mul_f32 v218, v251, v218
    v_mul_f32 v219, v251, v219
    v_mul_f32 v220, v251, v220
    v_mul_f32 v221, v251, v221
    v_mul_f32 v222, v251, v222
    v_mul_f32 v223, v251, v223
    v_cvt_pk_bf16_f32 v32, v216, v217
    v_cvt_pk_bf16_f32 v33, v218, v219
    v_cvt_pk_bf16_f32 v34, v220, v221
    v_cvt_pk_bf16_f32 v35, v222, v223
    v_mul_f32 v224, v251, v224
    v_mul_f32 v225, v251, v225
    v_mul_f32 v226, v251, v226
    v_mul_f32 v227, v251, v227
    v_mul_f32 v228, v251, v228
    v_mul_f32 v229, v251, v229
    v_mul_f32 v230, v251, v230
    v_mul_f32 v231, v251, v231
    v_cvt_pk_bf16_f32 v64, v224, v225
    v_cvt_pk_bf16_f32 v65, v226, v227
    v_cvt_pk_bf16_f32 v66, v228, v229
    v_cvt_pk_bf16_f32 v67, v230, v231
    v_mov_b32 v251, 0x2b800000
    v_mov_b32 v250, 0
    v_mov_b32 v217, s78
    v_mov_b32 v208, 0
    v_mov_b32 v209, 0
    v_mov_b32 v210, 0
    v_mov_b32 v211, 0
    v_mov_b32 v212, 0
    v_mov_b32 v213, 0
    v_mov_b32 v214, 0
    v_mov_b32 v215, 0
    v_mbcnt_lo_u32_b32 v0, -1, 0
    v_mbcnt_hi_u32_b32 v0, -1, v0
    s_lshl_b32 s31, s29, 9
    v_and_b32 v1, 32, v0
    s_lshl_b32 s32, s30, 6
    v_mul_u32_u24 v1, 6, v1
    s_add_u32 s31, s31, s32
    v_lshl_add_u32 v0, v0, 1, v1
    v_add_u32 v0, s31, v0
    s_and_b32 s31, vcc_lo, 0x7f
    s_bcnt1_i32_b32 s74, s31
    s_and_b32 s31, vcc_lo, 0x3fff
    s_bcnt1_i32_b32 s76, s31
    s_sub_u32 s68, 14, s76
    s_sub_u32 s69, 7, s74
    s_mul_i32 s31, s29, 8704
    s_mul_i32 s34, s30, 2176
    s_add_u32 s34, s34, s31
    s_waitcnt vmcnt(0) lgkmcnt(0)
    s_barrier
    s_mov_b32 s67, 0
L_slow_pre:
    s_call_b64 s[70:71], L_slow_dma
    s_cmp_lt_u32 s67, 6
    s_cbranch_scc1 L_slow_pre
    s_mov_b32 s77, 0
L_slow_loop:
    s_waitcnt vmcnt(10) lgkmcnt(0)
    s_barrier
    s_call_b64 s[70:71], L_slow_dma
    s_cmp_eq_u32 s77, 0
    s_cbranch_scc1 L_slow_nog2
    s_sub_u32 s31, s77, 1
    s_and_b32 s65, s31, 7
    s_mul_i32 s65, s65, 17408
    s_cmp_lt_u32 s31, s74
    s_cselect_b32 s32, 0, 512
    s_and_b32 s31, s31, 1
    s_mul_i32 s31, s31, 1536
    s_add_u32 s31, s31, s32
    v_add_u32 v255, s31, v245
    v_add_u32 v240, s65, v236
    v_add_u32 v241, s65, v237
    v_add_u32 v242, s65, v238
    v_add_u32 v243, s65, v239
    ds_read_b128 v[196:199], v255
    ds_read_b64_tr_b16 v[200:201], v240 offset:0
    ds_read_b64_tr_b16 v[202:203], v241 offset:256
    ds_read_b64_tr_b16 v[204:205], v242 offset:0
    ds_read_b64_tr_b16 v[206:207], v243 offset:256
    s_waitcnt lgkmcnt(0)
    v_mfma_f32_16x16x32_bf16 v[208:211], v[196:199], v[200:203], v[208:211]
    v_mfma_f32_16x16x32_bf16 v[212:215], v[196:199], v[204:207], v[212:215]
L_slow_nog2:
    s_cmp_eq_u32 s77, s76
    s_cbranch_scc1 L_epi
    s_and_b32 s64, s77, 7
    s_mul_i32 s64, s64, 17408
    v_add_u32 v233, s64, v232
    v_add_u32 v235, s64, v234
    s_cmp_lt_u32 s77, s74
    s_cselect_b32 s31, s69, s68
    s_add_u32 s31, s31, s77
    s_lshl_b32 s31, s31, 7
    v_add_u32 v255, s31, v246
    ds_read_b128 v[116:119], v233 offset:0
    ds_read_b128 v[120:123], v235 offset:0
    ds_read_b128 v[124:127], v233 offset:64
    ds_read_b128 v[128:131], v235 offset:64
    ds_read_b128 v[132:135], v233 offset:128
    ds_read_b128 v[136:139], v235 offset:128
    ds_read_b128 v[140:143], v233 offset:192
    ds_read_b128 v[144:147], v235 offset:192
    ds_read_u16_d16_hi v250, v255 offset:2
    s_and_b32 s31, s77, 1
    s_mul_i32 s31, s31, 1536
    s_waitcnt lgkmcnt(0)
    s_cmp_lt_u32 s77, s74
    s_cbranch_scc0 L_slow_B
    v_mfma_f32_32x32x16_bf16 v[148:163], v[4:7], v[116:119], v[68:83]
    v_mfma_f32_32x32x16_bf16 v[148:163], v[8:11], v[120:123], v[148:163]
    v_mfma_f32_32x32x16_bf16 v[148:163], v[12:15], v[124:127], v[148:163]
    v_mfma_f32_32x32x16_bf16 v[148:163], v[16:19], v[128:131], v[148:163]
    v_mfma_f32_32x32x16_bf16 v[148:163], v[20:23], v[132:135], v[148:163]
    v_mfma_f32_32x32x16_bf16 v[148:163], v[24:27], v[136:139], v[148:163]
    v_mfma_f32_32x32x16_bf16 v[148:163], v[28:31], v[140:143], v[148:163]
    v_mfma_f32_32x32x16_bf16 v[148:163], v[32:35], v[144:147], v[148:163]
    v_add_u32 v255, s31, v244
    s_nop 11
    s_branch L_slow_sig
L_slow_B:
    v_mfma_f32_32x32x16_bf16 v[148:163], v[36:39], v[116:119], v[84:99]
    v_mfma_f32_32x32x16_bf16 v[148:163], v[40:43], v[120:123], v[148:163]
    v_mfma_f32_32x32x16_bf16 v[148:163], v[44:47], v[124:127], v[148:163]
    v_mfma_f32_32x32x16_bf16 v[148:163], v[48:51], v[128:131], v[148:163]
    v_mfma_f32_32x32x16_bf16 v[148:163], v[52:55], v[132:135], v[148:163]
    v_mfma_f32_32x32x16_bf16 v[148:163], v[56:59], v[136:139], v[148:163]
    v_mfma_f32_32x32x16_bf16 v[148:163], v[60:63], v[140:143], v[148:163]
    v_mfma_f32_32x32x16_bf16 v[148:163], v[64:67], v[144:147], v[148:163]
    s_add_u32 s31, s31, 1024
    v_add_u32 v255, s31, v247
    s_nop 11
L_slow_sig:
    v_exp_f32_e64 v148, v148 clamp
    v_exp_f32_e64 v149, v149 clamp
    v_exp_f32_e64 v150, v150 clamp
    v_exp_f32_e64 v151, v151 clamp
    v_exp_f32_e64 v152, v152 clamp
    v_exp_f32_e64 v153, v153 clamp
    v_exp_f32_e64 v154, v154 clamp
    v_exp_f32_e64 v155, v155 clamp
    v_exp_f32_e64 v156, v156 clamp
    v_exp_f32_e64 v157, v157 clamp
    v_exp_f32_e64 v158, v158 clamp
    v_exp_f32_e64 v159, v159 clamp
    v_exp_f32_e64 v160, v160 clamp
    v_exp_f32_e64 v161, v161 clamp
    v_exp_f32_e64 v162, v162 clamp
    v_exp_f32_e64 v163, v163 clamp
    v_add_f32 v148, v251, v148
    v_add_f32 v149, v251, v149
    v_add_f32 v150, v251, v150
    v_add_f32 v151, v251, v151
    v_add_f32 v152, v251, v152
    v_add_f32 v153, v251, v153
    v_add_f32 v154, v251, v154
    v_add_f32 v155, v251, v155
    v_add_f32 v156, v251, v156
    v_add_f32 v157, v251, v157
    v_add_f32 v158, v251, v158
    v_add_f32 v159, v251, v159
    v_add_f32 v160, v251, v160
    v_add_f32 v161, v251, v161
    v_add_f32 v162, v251, v162
    v_add_f32 v163, v251, v163
    v_mul_f32 v180, v148, v149
    v_mul_f32 v181, v150, v151
    v_mul_f32 v182, v152, v153
    v_mul_f32 v183, v154, v155
    v_mul_f32 v184, v156, v157
    v_mul_f32 v185, v158, v159
    v_mul_f32 v186, v160, v161
    v_mul_f32 v187, v162, v163
    v_mul_f32 v188, v148, v101
    v_mul_f32 v189, v150, v103
    v_mul_f32 v190, v152, v105
    v_mul_f32 v191, v154, v107
    v_mul_f32 v192, v156, v109
    v_mul_f32 v193, v158, v111
    v_mul_f32 v194, v160, v113
    v_mul_f32 v195, v162, v115
    v_fmac_f32 v188, v149, v100
    v_fmac_f32 v189, v151, v102
    v_fmac_f32 v190, v153, v104
    v_fmac_f32 v191, v155, v106
    v_fmac_f32 v192, v157, v108
    v_fmac_f32 v193, v159, v110
    v_fmac_f32 v194, v161, v112
    v_fmac_f32 v195, v163, v114
    v_rcp_f32 v180, v180
    v_rcp_f32 v181, v181
    v_rcp_f32 v182, v182
    v_rcp_f32 v183, v183
    v_rcp_f32 v184, v184
    v_rcp_f32 v185, v185
    v_rcp_f32 v186, v186
    v_rcp_f32 v187, v187
    v_fma_f32 v249, v188, v180, v248
    v_fmac_f32 v249, v189, v181
    v_fmac_f32 v249, v190, v182
    v_fmac_f32 v249, v191, v183
    v_fmac_f32 v249, v192, v184
    v_fmac_f32 v249, v193, v185
    v_fmac_f32 v249, v194, v186
    v_fmac_f32 v249, v195, v187
    v_mul_f32 v252, v249, v250
    v_add_u32 v252, v217, v252
    ds_write_b16_d16_hi v255, v252
    s_add_u32 s77, s77, 1
    s_branch L_slow_loop
L_slow_dma:
    s_cmp_lt_u32 s67, s74
    s_cselect_b32 s31, s69, s68
    s_add_u32 s31, s31, s67
    s_min_u32 s31, s31, 13
    s_lshl_b32 s31, s31, 7
    v_add_u32 v3, s31, v253
    ds_read_u16 v1, v3
    ds_read_u16 v2, v3 offset:16
    s_cmp_lt_u32 s67, s76
    s_cselect_b32 s66, 0, 0xffff
    s_and_b32 s31, s67, 7
    s_mul_i32 s31, s31, 17408
    s_add_u32 s31, s31, s34
    s_waitcnt lgkmcnt(0)
    v_or_b32 v1, s66, v1
    v_or_b32 v2, s66, v2
    v_lshl_add_u32 v1, v1, 8, v254
    v_lshl_add_u32 v2, v2, 8, v254
    s_mov_b32 m0, s31
    s_add_u32 s67, s67, 1
    buffer_load_dwordx4 v1, s[20:23], 0 offen lds
    s_add_u32 m0, s31, 1088
    s_nop 0
    buffer_load_dwordx4 v2, s[20:23], 0 offen lds
    s_setpc_b64 s[70:71]
L_end:
    .fill 1245, 4, 0xBF810000
.section .rodata,"a"
.p2align 6
.amdhsa_kernel standalone__sequential_behavior_din__recsys_kernel
  .amdhsa_next_free_vgpr 256
  .amdhsa_next_free_sgpr 102
  .amdhsa_accum_offset 256
  .amdhsa_group_segment_fixed_size 0
  .amdhsa_kernarg_size 80
  .amdhsa_user_sgpr_count 2
  .amdhsa_user_sgpr_kernarg_segment_ptr 1
  .amdhsa_system_sgpr_workgroup_id_x 1
.end_amdhsa_kernel
```
